```python
import torch

def _softmax(x, axis=-1):
    return torch.softmax(x, dim=axis)
def _gelu(x):
    return torch.nn.functional.gelu(x, approximate="tanh")
def _silu(x):
    return torch.nn.functional.silu(x)
def _sigmoid(x):
    return torch.sigmoid(x)
def _layernorm(x, axis=-1, eps=1e-5):
    m = x.mean(dim=axis, keepdim=True)
    v = x.var(dim=axis, keepdim=True, unbiased=False)
    return (x - m) / torch.sqrt(v + eps)
def _scatter_add(tgt, idx, src, axis=0):
    return tgt.clone().index_add_(axis, idx, src)
def _segment_sum(src, seg, n):
    out = torch.zeros((n,) + src.shape[1:], dtype=src.dtype)
    return out.index_add_(0, seg, src)
def _pad(x, pw):
    flat = tuple(v for pair in reversed(pw) for v in pair)
    return torch.nn.functional.pad(x, flat)

kernel_name = 'standalone__glu_gated_swiglu__prompt'

def setup_inputs():

    _w = (lambda a: (lambda t: t.to(torch.bfloat16) if t.is_floating_point() else t)(torch.as_tensor(a)))
    B, S, D, F = 1, 2048, 640, 1536
    return {
        "x": _w((lambda *s: torch.randn(*s, dtype=torch.bfloat16) * 0.05)(B, S, D)),
        "w1": _w((lambda *s: torch.randn(*s, dtype=torch.bfloat16) * 0.05)(D, F) * (2.0 / D) ** 0.5),
        "w3": _w((lambda *s: torch.randn(*s, dtype=torch.bfloat16) * 0.05)(D, F) * (2.0 / D) ** 0.5),
        "w2": _w((lambda *s: torch.randn(*s, dtype=torch.bfloat16) * 0.05)(F, D) * (2.0 / F) ** 0.5),
    }

def reference(x, w1, w3, w2):
    gate = torch.einsum("bsd,df->bsf", x, w1)
    up = torch.einsum("bsd,df->bsf", x, w3)
    h = _silu(gate) * up
    out = torch.einsum("bsf,fd->bsd", h, w2)
    return out
```

```asm
; @launch grid=(256,1,1) block=(256,1,1) lds=150528
.amdgcn_target "amdgcn-amd-amdhsa--gfx950"
.text
    .p2align 12
    .globl standalone__glu_gated_swiglu__prompt_kernel
    .p2align 8
    .type standalone__glu_gated_swiglu__prompt_kernel,@function
standalone__glu_gated_swiglu__prompt_kernel:
    s_cmp_ge_u32 s2, 256
    s_cbranch_scc1 L_end_standalone__glu_gated_swiglu__prompt_kernel
    s_getpc_b64 s[40:41]
    s_load_dwordx2 s[8:9], s[0:1], 8
    s_load_dwordx2 s[12:13], s[0:1], 16
    s_load_dwordx2 s[4:5], s[0:1], 0
    s_memrealtime s[42:43]
    s_load_dwordx2 s[16:17], s[0:1], 24
    s_load_dwordx2 s[28:29], s[0:1], 48
    s_load_dwordx2 s[32:33], s[0:1], 40
    s_load_dwordx2 s[20:21], s[0:1], 32
    s_load_dwordx2 s[24:25], s[0:1], 48
    s_load_dwordx2 s[36:37], s[0:1], 48
    v_lshrrev_b32 v4, 6, v0
    v_and_b32 v1, 63, v0
    v_readfirstlane_b32 s44, v4
    s_lshr_b32 s46, s2, 3
    v_lshrrev_b32 v5, 5, v0
    s_lshl_b32 s47, s46, 3
    v_add_u32 v5, s47, v5
    v_lshlrev_b32 v5, 7, v5
    s_and_b32 s40, s40, 0xffffff00
    v_min_u32 v5, L_codeend - standalone__glu_gated_swiglu__prompt_kernel - 4, v5
    global_load_dword v9, v5, s[40:41]
    s_and_b32 s45, s2, 7
    s_lshr_b32 s46, s2, 3
    s_mov_b32 s10, 1966080
    s_mov_b32 s11, 0x20000
    s_mov_b32 s14, 1968128
    s_mov_b32 s15, 0x20000
    s_cmp_ge_u32 s46, 30
    s_cbranch_scc1 L_spare
    s_mul_i32 s47, s46, 43
    s_lshr_b32 s47, s47, 8
    s_mul_i32 s48, s47, 6
    s_sub_u32 s48, s46, s48
    s_and_b32 s49, s45, 1
    s_mul_i32 s49, s49, 5
    s_add_u32 s72, s49, s47
    s_lshr_b32 s49, s45, 1
    s_mul_i32 s49, s49, 6
    s_add_u32 s73, s49, s48
    s_add_u32 s87, s47, s48
    s_mul_i32 s49, s87, 52
    s_lshr_b32 s49, s49, 8
    s_mul_i32 s49, s49, 5
    s_sub_u32 s87, s87, s49
    s_mov_b32 s74, 0
    s_cmp_eq_u32 s87, 0
    s_cselect_b32 s74, 1, s74
    s_lshl_b32 s74, s74, 7
    s_lshl_b32 s47, s44, 4
    v_lshrrev_b32 v7, 3, v1
    v_add_u32 v4, s47, v7
    v_mul_u32_u24 v4, 3072, v4
    v_and_b32 v6, 7, v1
    v_bfe_u32 v5, v1, 4, 1
    v_lshlrev_b32 v5, 1, v5
    v_xor_b32 v5, v5, v6
    v_lshl_add_u32 v4, v5, 4, v4
    s_lshl_b32 s47, s73, 7
    v_add_u32 v24, s47, v4
    v_xor_b32 v4, 64, v24
    v_add_u32 v25, 23552, v4
    s_lshl_b32 s86, s44, 12
    s_add_u32 s86, s86, 26624
    s_mul_i32 s47, s44, 52
    v_add_u32 v4, s47, v7
    v_bfe_u32 v5, v4, 1, 3
    v_xor_b32 v5, v5, v6
    s_mul_i32 s48, s72, 208
    v_add_u32 v4, s48, v4
    v_mul_u32_u24 v4, 1280, v4
    v_lshl_add_u32 v17, v5, 4, v4
    v_xor_b32 v5, 64, v17
    v_add_u32 v18, 9216, v5
    v_add_u32 v19, 18432, v17
    v_add_u32 v20, 27648, v5
    v_add_u32 v21, 40960, v17
    v_add_u32 v22, 50176, v5
    v_add_u32 v23, 59392, v17
    s_mul_i32 s85, s44, 6656
    s_mov_b32 s6, 2621440
    s_mov_b32 s7, 0x20000
    s_waitcnt lgkmcnt(0)
    s_sub_u32 s12, s12, 2048
    s_subb_u32 s13, s13, 0
    s_add_u32 m0, s86, 0
    s_mul_i32 s84, s74, 1536
    s_nop 0
    buffer_load_dwordx4 v24, s[8:11], s84 offen offset:0 lds
    buffer_load_dwordx4 v25, s[8:11], s84 offen offset:1024 lds
    buffer_load_dwordx4 v24, s[12:15], s84 offen offset:2048 lds
    buffer_load_dwordx4 v25, s[12:15], s84 offen offset:3072 lds
    s_add_u32 m0, s85, 0
    s_nop 0
    buffer_load_dwordx4 v17, s[4:7], s74 offen offset:0 lds
    buffer_load_dwordx4 v18, s[4:7], s74 offen offset:1024 lds
    buffer_load_dwordx4 v19, s[4:7], s74 offen offset:2048 lds
    buffer_load_dwordx4 v20, s[4:7], s74 offen offset:3072 lds
    s_add_u32 m0, s85, 4096
    s_nop 0
    buffer_load_dwordx4 v21, s[4:7], s74 offen offset:0 lds
    buffer_load_dwordx4 v22, s[4:7], s74 offen offset:1024 lds
    s_mov_b32 exec_hi, 0
    buffer_load_dwordx4 v23, s[4:7], s74 offen offset:2048 lds
    s_mov_b32 exec_hi, -1
    s_mov_b32 s75, 1
    s_cmp_eq_u32 s87, 0
    s_cselect_b32 s75, 0, s75
    s_cmp_eq_u32 s87, 1
    s_cselect_b32 s75, 2, s75
    s_lshl_b32 s75, s75, 7
    s_mov_b32 s34, 256
    s_mov_b32 s35, 0x20000
    s_waitcnt lgkmcnt(0)
    s_or_b32 s47, s2, s44
    s_cmp_lg_u32 s47, 0
    s_cbranch_scc1 L_notok
    s_max_u32 s47, s42, 1
    v_mov_b32 v4, s47
    s_mov_b64 exec, 1
    buffer_store_dword v4, off, s[32:35], 0 sc1
    s_mov_b64 exec, -1
L_notok:
    s_mov_b32 s76, 2
    s_cmp_eq_u32 s87, 1
    s_cselect_b32 s76, 1, s76
    s_cmp_eq_u32 s87, 2
    s_cselect_b32 s76, 3, s76
    s_lshl_b32 s76, s76, 7
    v_and_b32 v4, 15, v1
    v_bfe_u32 v5, v1, 1, 3
    v_lshrrev_b32 v6, 4, v1
    v_xor_b32 v5, v5, v6
    v_lshlrev_b32 v4, 7, v4
    v_lshl_add_u32 v216, v5, 4, v4
    v_xor_b32 v217, 64, v216
    v_bfe_u32 v4, v1, 5, 1
    v_mul_u32_u24 v222, 4096, v4
    v_bfe_u32 v4, v1, 4, 1
    v_mul_u32_u24 v5, 1024, v4
    v_add_u32 v222, v222, v5
    v_lshlrev_b32 v5, 2, v4
    v_bfe_u32 v4, v1, 3, 1
    v_lshl_add_u32 v5, v4, 1, v5
    v_bfe_u32 v4, v1, 1, 1
    s_lshl_b32 s47, s44, 1
    v_add_u32 v4, s47, v4
    v_xor_b32 v4, v4, v5
    v_lshl_add_u32 v222, v4, 4, v222
    v_bfe_u32 v4, v1, 2, 2
    v_lshl_add_u32 v222, v4, 7, v222
    v_and_b32 v4, 1, v1
    v_lshl_add_u32 v222, v4, 3, v222
    v_add_u32 v222, 26624, v222
    s_add_u32 m0, s86, 43008
    s_mul_i32 s84, s75, 1536
    s_nop 0
    buffer_load_dwordx4 v24, s[8:11], s84 offen offset:0 lds
    buffer_load_dwordx4 v25, s[8:11], s84 offen offset:1024 lds
    buffer_load_dwordx4 v24, s[12:15], s84 offen offset:2048 lds
    buffer_load_dwordx4 v25, s[12:15], s84 offen offset:3072 lds
    s_add_u32 m0, s85, 43008
    s_nop 0
    buffer_load_dwordx4 v17, s[4:7], s75 offen offset:0 lds
    buffer_load_dwordx4 v18, s[4:7], s75 offen offset:1024 lds
    buffer_load_dwordx4 v19, s[4:7], s75 offen offset:2048 lds
    buffer_load_dwordx4 v20, s[4:7], s75 offen offset:3072 lds
    s_add_u32 m0, s85, 47104
    s_nop 0
    buffer_load_dwordx4 v21, s[4:7], s75 offen offset:0 lds
    s_waitcnt vmcnt(9)
    s_barrier
    ds_read_b64_tr_b16 v[176:177], v222 offset:0
    ds_read_b64_tr_b16 v[178:179], v222 offset:512
    ds_read_b64_tr_b16 v[180:181], v222 offset:2048
    ds_read_b64_tr_b16 v[182:183], v222 offset:2560
    ds_read_b128 v[132:135], v216 offset:0
    ds_read_b128 v[136:139], v216 offset:2048
    ds_read_b128 v[140:143], v216 offset:4096
    ds_read_b128 v[144:147], v216 offset:6144
    ds_read_b128 v[148:151], v216 offset:8192
    ds_read_b128 v[152:155], v216 offset:10240
    ds_read_b128 v[156:159], v216 offset:12288
    ds_read_b128 v[160:163], v216 offset:14336
    ds_read_b128 v[164:167], v216 offset:16384
    s_waitcnt lgkmcnt(8)
    v_mfma_f32_16x16x32_bf16 v[28:31], v[176:179], v[132:135], 0
    buffer_load_dwordx4 v22, s[4:7], s75 offen offset:1024 lds
    v_mfma_f32_16x16x32_bf16 v[32:35], v[180:183], v[132:135], 0
    s_waitcnt lgkmcnt(7)
    ds_read_b128 v[168:171], v216 offset:18432
    s_mov_b32 s77, 3
    v_mfma_f32_16x16x32_bf16 v[36:39], v[176:179], v[136:139], 0
    s_mov_b32 exec_hi, 0
    buffer_load_dwordx4 v23, s[4:7], s75 offen offset:2048 lds
    s_mov_b32 exec_hi, -1
    v_mfma_f32_16x16x32_bf16 v[40:43], v[180:183], v[136:139], 0
    s_waitcnt lgkmcnt(7)
    ds_read_b128 v[172:175], v216 offset:20480
    s_add_u32 m0, s86, 86016
    s_mul_i32 s84, s76, 1536
    v_mfma_f32_16x16x32_bf16 v[44:47], v[176:179], v[140:143], 0
    buffer_load_dwordx4 v24, s[8:11], s84 offen offset:0 lds
    v_mfma_f32_16x16x32_bf16 v[48:51], v[180:183], v[140:143], 0
    s_waitcnt lgkmcnt(7)
    ds_read_b128 v[132:135], v216 offset:22528
    s_cmp_eq_u32 s87, 2
    s_cselect_b32 s77, 2, s77
    v_mfma_f32_16x16x32_bf16 v[52:55], v[176:179], v[144:147], 0
    ds_read_b128 v[136:139], v216 offset:24576
    s_cmp_eq_u32 s87, 3
    s_cselect_b32 s77, 4, s77
    v_mfma_f32_16x16x32_bf16 v[56:59], v[180:183], v[144:147], 0
    s_waitcnt lgkmcnt(8)
    buffer_load_dwordx4 v25, s[8:11], s84 offen offset:1024 lds
    v_mfma_f32_16x16x32_bf16 v[60:63], v[176:179], v[148:151], 0
    ds_read_b64_tr_b16 v[184:185], v222 offset:8192
    s_lshl_b32 s77, s77, 7
    v_mfma_f32_16x16x32_bf16 v[64:67], v[180:183], v[148:151], 0
    s_waitcnt lgkmcnt(8)
    ds_read_b64_tr_b16 v[186:187], v222 offset:8704
    v_add_u32 v218, 43008, v216
    v_mfma_f32_16x16x32_bf16 v[68:71], v[176:179], v[152:155], 0
    buffer_load_dwordx4 v24, s[12:15], s84 offen offset:2048 lds
    v_mfma_f32_16x16x32_bf16 v[72:75], v[180:183], v[152:155], 0
    s_waitcnt lgkmcnt(8)
    ds_read_b64_tr_b16 v[188:189], v222 offset:10240
    v_add_u32 v219, 43008, v217
    v_mfma_f32_16x16x32_bf16 v[76:79], v[176:179], v[156:159], 0
    ds_read_b64_tr_b16 v[190:191], v222 offset:10752
    v_add_u32 v220, 86016, v216
    v_mfma_f32_16x16x32_bf16 v[80:83], v[180:183], v[156:159], 0
    s_waitcnt lgkmcnt(9)
    buffer_load_dwordx4 v25, s[12:15], s84 offen offset:3072 lds
    v_mfma_f32_16x16x32_bf16 v[84:87], v[176:179], v[160:163], 0
    ds_read_b128 v[140:143], v217 offset:0
    s_add_u32 m0, s85, 86016
    v_mfma_f32_16x16x32_bf16 v[88:91], v[180:183], v[160:163], 0
    s_waitcnt lgkmcnt(9)
    ds_read_b128 v[144:147], v217 offset:2048
    v_add_u32 v221, 86016, v217
    v_mfma_f32_16x16x32_bf16 v[92:95], v[176:179], v[164:167], 0
    buffer_load_dwordx4 v17, s[4:7], s76 offen offset:0 lds
    v_mfma_f32_16x16x32_bf16 v[96:99], v[180:183], v[164:167], 0
    s_waitcnt lgkmcnt(9)
    ds_read_b128 v[148:151], v217 offset:4096
    v_add_u32 v223, 43008, v222
    v_mfma_f32_16x16x32_bf16 v[100:103], v[176:179], v[168:171], 0
    ds_read_b128 v[152:155], v217 offset:6144
    v_add_u32 v224, 86016, v222
    v_mfma_f32_16x16x32_bf16 v[104:107], v[180:183], v[168:171], 0
    s_waitcnt lgkmcnt(10)
    buffer_load_dwordx4 v18, s[4:7], s76 offen offset:1024 lds
    v_mfma_f32_16x16x32_bf16 v[108:111], v[176:179], v[172:175], 0
    ds_read_b128 v[156:159], v217 offset:8192
    s_mov_b32 s18, 1966080
    v_mfma_f32_16x16x32_bf16 v[112:115], v[180:183], v[172:175], 0
    s_waitcnt lgkmcnt(10)
    ds_read_b128 v[160:163], v217 offset:10240
    s_mov_b32 s19, 0x20000
    v_mfma_f32_16x16x32_bf16 v[116:119], v[176:179], v[132:135], 0
    buffer_load_dwordx4 v19, s[4:7], s76 offen offset:2048 lds
    v_mfma_f32_16x16x32_bf16 v[120:123], v[180:183], v[132:135], 0
    s_waitcnt lgkmcnt(10)
    ds_read_b128 v[164:167], v217 offset:12288
    s_mov_b32 s22, 2621440
    v_mfma_f32_16x16x32_bf16 v[124:127], v[176:179], v[136:139], 0
    ds_read_b128 v[168:171], v217 offset:14336
    s_mov_b32 s23, 0x20000
    v_mfma_f32_16x16x32_bf16 v[128:131], v[180:183], v[136:139], 0
    s_waitcnt lgkmcnt(7)
    buffer_load_dwordx4 v20, s[4:7], s76 offen offset:3072 lds
    v_mfma_f32_16x16x32_bf16 v[28:31], v[184:187], v[140:143], v[28:31]
    ds_read_b128 v[172:175], v217 offset:16384
    s_add_u32 m0, s85, 90112
    v_mfma_f32_16x16x32_bf16 v[32:35], v[188:191], v[140:143], v[32:35]
    s_waitcnt lgkmcnt(7)
    ds_read_b128 v[132:135], v217 offset:18432
    s_mov_b32 s26, 6291456
    v_mfma_f32_16x16x32_bf16 v[36:39], v[184:187], v[144:147], v[36:39]
    buffer_load_dwordx4 v21, s[4:7], s76 offen offset:0 lds
    v_mfma_f32_16x16x32_bf16 v[40:43], v[188:191], v[144:147], v[40:43]
    s_waitcnt lgkmcnt(7)
    ds_read_b128 v[136:139], v217 offset:20480
    s_mov_b32 s27, 0x20000
    v_mfma_f32_16x16x32_bf16 v[44:47], v[184:187], v[148:151], v[44:47]
    ds_read_b128 v[140:143], v217 offset:22528
    s_mov_b32 s30, 1966080
    v_mfma_f32_16x16x32_bf16 v[48:51], v[188:191], v[148:151], v[48:51]
    s_waitcnt lgkmcnt(8)
    buffer_load_dwordx4 v22, s[4:7], s76 offen offset:1024 lds
    v_mfma_f32_16x16x32_bf16 v[52:55], v[184:187], v[152:155], v[52:55]
    ds_read_b128 v[144:147], v217 offset:24576
    s_mov_b32 s31, 0x20000
    v_mfma_f32_16x16x32_bf16 v[56:59], v[188:191], v[152:155], v[56:59]
    s_waitcnt lgkmcnt(8)
    s_mov_b32 s38, 262144
    s_mov_b32 s39, 0x20000
    v_mfma_f32_16x16x32_bf16 v[60:63], v[184:187], v[156:159], v[60:63]
    s_mov_b32 exec_hi, 0
    buffer_load_dwordx4 v23, s[4:7], s76 offen offset:2048 lds
    s_mov_b32 exec_hi, -1
    v_mfma_f32_16x16x32_bf16 v[64:67], v[188:191], v[156:159], v[64:67]
    s_waitcnt lgkmcnt(7)
    s_add_u32 s28, s28, 8388608
    s_addc_u32 s29, s29, 0
    s_add_u32 s36, s36, 12582912
    s_addc_u32 s37, s37, 0
    v_mfma_f32_16x16x32_bf16 v[68:71], v[184:187], v[160:163], v[68:71]
    s_mov_b32 s78, 4
    v_mfma_f32_16x16x32_bf16 v[72:75], v[188:191], v[160:163], v[72:75]
    s_waitcnt lgkmcnt(6)
    s_cmp_eq_u32 s87, 3
    s_cselect_b32 s78, 3, s78
    s_cmp_eq_u32 s87, 4
    s_cselect_b32 s78, 5, s78
    v_mfma_f32_16x16x32_bf16 v[76:79], v[184:187], v[164:167], v[76:79]
    s_waitcnt vmcnt(11) lgkmcnt(0)
    s_barrier
    v_mfma_f32_16x16x32_bf16 v[80:83], v[188:191], v[164:167], v[80:83]
    ds_read_b64_tr_b16 v[192:193], v223 offset:0
    s_add_u32 m0, s86, 0
    s_mul_i32 s84, s77, 1536
    v_mfma_f32_16x16x32_bf16 v[84:87], v[184:187], v[168:171], v[84:87]
    buffer_load_dwordx4 v24, s[8:11], s84 offen offset:0 lds
    v_mfma_f32_16x16x32_bf16 v[88:91], v[188:191], v[168:171], v[88:91]
    ds_read_b64_tr_b16 v[194:195], v223 offset:512
    s_lshl_b32 s78, s78, 7
    v_mfma_f32_16x16x32_bf16 v[92:95], v[184:187], v[172:175], v[92:95]
    ds_read_b64_tr_b16 v[196:197], v223 offset:2048
    v_mfma_f32_16x16x32_bf16 v[96:99], v[188:191], v[172:175], v[96:99]
    buffer_load_dwordx4 v25, s[8:11], s84 offen offset:1024 lds
    v_mfma_f32_16x16x32_bf16 v[100:103], v[184:187], v[132:135], v[100:103]
    ds_read_b64_tr_b16 v[198:199], v223 offset:2560
    s_mov_b32 s79, 5
    v_mfma_f32_16x16x32_bf16 v[104:107], v[188:191], v[132:135], v[104:107]
    ds_read_b128 v[148:151], v218 offset:0
    s_cmp_eq_u32 s87, 0
    s_cselect_b32 s79, 6, s79
    v_mfma_f32_16x16x32_bf16 v[108:111], v[184:187], v[136:139], v[108:111]
    ds_read_b128 v[152:155], v218 offset:2048
    s_cmp_eq_u32 s87, 4
    s_cselect_b32 s79, 4, s79
    v_mfma_f32_16x16x32_bf16 v[112:115], v[188:191], v[136:139], v[112:115]
    buffer_load_dwordx4 v24, s[12:15], s84 offen offset:2048 lds
    v_mfma_f32_16x16x32_bf16 v[116:119], v[184:187], v[140:143], v[116:119]
    ds_read_b128 v[156:159], v218 offset:4096
    s_lshl_b32 s79, s79, 7
    v_mfma_f32_16x16x32_bf16 v[120:123], v[188:191], v[140:143], v[120:123]
    ds_read_b128 v[160:163], v218 offset:6144
    s_mov_b32 s80, 6
    v_mfma_f32_16x16x32_bf16 v[124:127], v[184:187], v[144:147], v[124:127]
    ds_read_b128 v[164:167], v218 offset:8192
    s_cmp_eq_u32 s87, 0
    s_cselect_b32 s80, 5, s80
    v_mfma_f32_16x16x32_bf16 v[128:131], v[188:191], v[144:147], v[128:131]
    s_waitcnt lgkmcnt(4)
    buffer_load_dwordx4 v25, s[12:15], s84 offen offset:3072 lds
    v_mfma_f32_16x16x32_bf16 v[28:31], v[192:195], v[148:151], v[28:31]
    ds_read_b128 v[168:171], v218 offset:10240
    s_add_u32 m0, s85, 0
    v_mfma_f32_16x16x32_bf16 v[32:35], v[196:199], v[148:151], v[32:35]
    s_waitcnt lgkmcnt(4)
    ds_read_b128 v[172:175], v218 offset:12288
    s_cmp_eq_u32 s87, 1
    s_cselect_b32 s80, 7, s80
    v_mfma_f32_16x16x32_bf16 v[36:39], v[192:195], v[152:155], v[36:39]
    ds_read_b128 v[132:135], v218 offset:14336
    s_lshl_b32 s80, s80, 7
    v_mfma_f32_16x16x32_bf16 v[40:43], v[196:199], v[152:155], v[40:43]
    s_waitcnt lgkmcnt(5)
    buffer_load_dwordx4 v17, s[4:7], s77 offen offset:0 lds
    v_mfma_f32_16x16x32_bf16 v[44:47], v[192:195], v[156:159], v[44:47]
    ds_read_b128 v[136:139], v218 offset:16384
    s_mov_b32 s81, 7
    v_mfma_f32_16x16x32_bf16 v[48:51], v[196:199], v[156:159], v[48:51]
    s_waitcnt lgkmcnt(5)
    ds_read_b128 v[140:143], v218 offset:18432
    s_cmp_eq_u32 s87, 1
    s_cselect_b32 s81, 6, s81
    v_mfma_f32_16x16x32_bf16 v[52:55], v[192:195], v[160:163], v[52:55]
    ds_read_b128 v[144:147], v218 offset:20480
    s_cmp_eq_u32 s87, 2
    s_cselect_b32 s81, 8, s81
    v_mfma_f32_16x16x32_bf16 v[56:59], v[196:199], v[160:163], v[56:59]
    s_waitcnt lgkmcnt(6)
    buffer_load_dwordx4 v18, s[4:7], s77 offen offset:1024 lds
    v_mfma_f32_16x16x32_bf16 v[60:63], v[192:195], v[164:167], v[60:63]
    ds_read_b128 v[148:151], v218 offset:22528
    s_lshl_b32 s81, s81, 7
    v_mfma_f32_16x16x32_bf16 v[64:67], v[196:199], v[164:167], v[64:67]
    s_waitcnt lgkmcnt(6)
    ds_read_b128 v[152:155], v218 offset:24576
    s_mov_b32 s82, 8
    v_mfma_f32_16x16x32_bf16 v[68:71], v[192:195], v[168:171], v[68:71]
    ds_read_b64_tr_b16 v[200:201], v223 offset:8192
    s_cmp_eq_u32 s87, 2
    s_cselect_b32 s82, 7, s82
    v_mfma_f32_16x16x32_bf16 v[72:75], v[196:199], v[168:171], v[72:75]
    s_waitcnt lgkmcnt(7)
    buffer_load_dwordx4 v19, s[4:7], s77 offen offset:2048 lds
    v_mfma_f32_16x16x32_bf16 v[76:79], v[192:195], v[172:175], v[76:79]
    ds_read_b64_tr_b16 v[202:203], v223 offset:8704
    s_cmp_eq_u32 s87, 3
    s_cselect_b32 s82, 9, s82
    v_mfma_f32_16x16x32_bf16 v[80:83], v[196:199], v[172:175], v[80:83]
    s_waitcnt lgkmcnt(7)
    ds_read_b64_tr_b16 v[204:205], v223 offset:10240
    s_lshl_b32 s82, s82, 7
    v_mfma_f32_16x16x32_bf16 v[84:87], v[192:195], v[132:135], v[84:87]
    ds_read_b64_tr_b16 v[206:207], v223 offset:10752
    s_mov_b32 s83, 9
    v_mfma_f32_16x16x32_bf16 v[88:91], v[196:199], v[132:135], v[88:91]
    s_waitcnt lgkmcnt(8)
    buffer_load_dwordx4 v20, s[4:7], s77 offen offset:3072 lds
    v_mfma_f32_16x16x32_bf16 v[92:95], v[192:195], v[136:139], v[92:95]
    ds_read_b128 v[156:159], v219 offset:0
    s_add_u32 m0, s85, 4096
    v_mfma_f32_16x16x32_bf16 v[96:99], v[196:199], v[136:139], v[96:99]
    s_waitcnt lgkmcnt(8)
    ds_read_b128 v[160:163], v219 offset:2048
    s_cmp_eq_u32 s87, 3
    s_cselect_b32 s83, 8, s83
    v_mfma_f32_16x16x32_bf16 v[100:103], v[192:195], v[140:143], v[100:103]
    ds_read_b128 v[164:167], v219 offset:4096
    s_lshl_b32 s83, s83, 7
    v_mfma_f32_16x16x32_bf16 v[104:107], v[196:199], v[140:143], v[104:107]
    s_waitcnt lgkmcnt(9)
    buffer_load_dwordx4 v21, s[4:7], s77 offen offset:0 lds
    v_mfma_f32_16x16x32_bf16 v[108:111], v[192:195], v[144:147], v[108:111]
    ds_read_b128 v[168:171], v219 offset:6144
    v_mfma_f32_16x16x32_bf16 v[112:115], v[196:199], v[144:147], v[112:115]
    s_waitcnt lgkmcnt(9)
    ds_read_b128 v[172:175], v219 offset:8192
    s_mov_b32 s89, 0xbfb8aa3b
    v_mfma_f32_16x16x32_bf16 v[116:119], v[192:195], v[148:151], v[116:119]
    ds_read_b128 v[132:135], v219 offset:10240
    v_bfe_u32 v4, v1, 4, 1
    v_mfma_f32_16x16x32_bf16 v[120:123], v[196:199], v[148:151], v[120:123]
    s_waitcnt lgkmcnt(10)
    buffer_load_dwordx4 v22, s[4:7], s77 offen offset:1024 lds
    v_mfma_f32_16x16x32_bf16 v[124:127], v[192:195], v[152:155], v[124:127]
    ds_read_b128 v[136:139], v219 offset:12288
    v_mul_u32_u24 v225, 49152, v4
    v_mfma_f32_16x16x32_bf16 v[128:131], v[196:199], v[152:155], v[128:131]
    s_waitcnt lgkmcnt(6)
    ds_read_b128 v[140:143], v219 offset:14336
    v_bfe_u32 v4, v1, 5, 1
    v_mfma_f32_16x16x32_bf16 v[28:31], v[200:203], v[156:159], v[28:31]
    ds_read_b128 v[144:147], v219 offset:16384
    v_lshl_add_u32 v225, v4, 8, v225
    v_mfma_f32_16x16x32_bf16 v[32:35], v[204:207], v[156:159], v[32:35]
    s_waitcnt lgkmcnt(7)
    ds_read_b128 v[148:151], v219 offset:18432
    v_and_b32 v4, 15, v1
    v_mfma_f32_16x16x32_bf16 v[36:39], v[200:203], v[160:163], v[36:39]
    s_mov_b32 exec_hi, 0
    buffer_load_dwordx4 v23, s[4:7], s77 offen offset:2048 lds
    s_mov_b32 exec_hi, -1
    v_mfma_f32_16x16x32_bf16 v[40:43], v[204:207], v[160:163], v[40:43]
    s_waitcnt lgkmcnt(7)
    ds_read_b128 v[152:155], v219 offset:20480
    v_lshl_add_u32 v225, v4, 4, v225
    v_mfma_f32_16x16x32_bf16 v[44:47], v[200:203], v[164:167], v[44:47]
    ds_read_b128 v[156:159], v219 offset:22528
    s_mul_i32 s47, s72, 638976
    v_mfma_f32_16x16x32_bf16 v[48:51], v[204:207], v[164:167], v[48:51]
    s_waitcnt lgkmcnt(8)
    s_lshl_b32 s48, s73, 11
    s_add_u32 s47, s47, s48
    v_mfma_f32_16x16x32_bf16 v[52:55], v[200:203], v[168:171], v[52:55]
    ds_read_b128 v[160:163], v219 offset:24576
    s_lshl_b32 s48, s44, 9
    v_mfma_f32_16x16x32_bf16 v[56:59], v[204:207], v[168:171], v[56:59]
    s_waitcnt lgkmcnt(8)
    s_add_u32 s47, s47, s48
    v_add_u32 v225, s47, v225
    v_mfma_f32_16x16x32_bf16 v[60:63], v[200:203], v[172:175], v[60:63]
    s_lshr_b32 s47, s45, 1
    s_mul_i32 s48, s47, 6
    v_mfma_f32_16x16x32_bf16 v[64:67], v[204:207], v[172:175], v[64:67]
    s_waitcnt lgkmcnt(7)
    s_sub_u32 s48, s73, s48
    s_lshl_b32 s49, s72, 2
    v_mfma_f32_16x16x32_bf16 v[68:71], v[200:203], v[132:135], v[68:71]
    s_add_u32 s47, s47, s49
    s_lshl_b32 s47, s47, 10
    v_mfma_f32_16x16x32_bf16 v[72:75], v[204:207], v[132:135], v[72:75]
    s_waitcnt lgkmcnt(6)
    s_mul_i32 s48, s48, 4
    s_add_u32 s51, s47, s48
    v_mfma_f32_16x16x32_bf16 v[76:79], v[200:203], v[136:139], v[76:79]
    s_waitcnt vmcnt(11) lgkmcnt(0)
    s_barrier
    v_mfma_f32_16x16x32_bf16 v[80:83], v[204:207], v[136:139], v[80:83]
    ds_read_b64_tr_b16 v[208:209], v224 offset:0
    s_add_u32 m0, s86, 43008
    s_mul_i32 s84, s78, 1536
    v_mfma_f32_16x16x32_bf16 v[84:87], v[200:203], v[140:143], v[84:87]
    buffer_load_dwordx4 v24, s[8:11], s84 offen offset:0 lds
    v_mfma_f32_16x16x32_bf16 v[88:91], v[204:207], v[140:143], v[88:91]
    ds_read_b64_tr_b16 v[210:211], v224 offset:512
    s_and_b32 s54, s45, 3
    v_mfma_f32_16x16x32_bf16 v[92:95], v[200:203], v[144:147], v[92:95]
    ds_read_b64_tr_b16 v[212:213], v224 offset:2048
    s_lshl_b32 s54, s54, 3
    v_mfma_f32_16x16x32_bf16 v[96:99], v[204:207], v[144:147], v[96:99]
    buffer_load_dwordx4 v25, s[8:11], s84 offen offset:1024 lds
    v_mfma_f32_16x16x32_bf16 v[100:103], v[200:203], v[148:151], v[100:103]
    ds_read_b64_tr_b16 v[214:215], v224 offset:2560
    s_and_b32 s47, s46, 7
    v_mfma_f32_16x16x32_bf16 v[104:107], v[204:207], v[148:151], v[104:107]
    ds_read_b128 v[164:167], v220 offset:0
    s_add_u32 s54, s54, s47
    v_mfma_f32_16x16x32_bf16 v[108:111], v[200:203], v[152:155], v[108:111]
    ds_read_b128 v[168:171], v220 offset:2048
    s_lshr_b32 s55, s45, 2
    v_mfma_f32_16x16x32_bf16 v[112:115], v[204:207], v[152:155], v[112:115]
    buffer_load_dwordx4 v24, s[12:15], s84 offen offset:2048 lds
    v_mfma_f32_16x16x32_bf16 v[116:119], v[200:203], v[156:159], v[116:119]
    ds_read_b128 v[172:175], v220 offset:4096
    s_lshl_b32 s55, s55, 2
    v_mfma_f32_16x16x32_bf16 v[120:123], v[204:207], v[156:159], v[120:123]
    ds_read_b128 v[132:135], v220 offset:6144
    s_lshr_b32 s47, s46, 3
    v_mfma_f32_16x16x32_bf16 v[124:127], v[200:203], v[160:163], v[124:127]
    ds_read_b128 v[136:139], v220 offset:8192
    s_add_u32 s55, s55, s47
    v_mfma_f32_16x16x32_bf16 v[128:131], v[204:207], v[160:163], v[128:131]
    s_waitcnt lgkmcnt(4)
    buffer_load_dwordx4 v25, s[12:15], s84 offen offset:3072 lds
    v_mfma_f32_16x16x32_bf16 v[28:31], v[208:211], v[164:167], v[28:31]
    ds_read_b128 v[140:143], v220 offset:10240
    s_add_u32 m0, s85, 43008
    v_mfma_f32_16x16x32_bf16 v[32:35], v[212:215], v[164:167], v[32:35]
    s_waitcnt lgkmcnt(4)
    ds_read_b128 v[144:147], v220 offset:12288
    s_mul_i32 s47, s44, 12288
    v_mfma_f32_16x16x32_bf16 v[36:39], v[208:211], v[168:171], v[36:39]
    ds_read_b128 v[148:151], v220 offset:14336
    v_lshlrev_b32 v4, 4, v1
    v_mfma_f32_16x16x32_bf16 v[40:43], v[212:215], v[168:171], v[40:43]
    s_waitcnt lgkmcnt(5)
    buffer_load_dwordx4 v17, s[4:7], s78 offen offset:0 lds
    v_mfma_f32_16x16x32_bf16 v[44:47], v[208:211], v[172:175], v[44:47]
    ds_read_b128 v[152:155], v220 offset:16384
    v_add_u32 v11, s47, v4
    v_mfma_f32_16x16x32_bf16 v[48:51], v[212:215], v[172:175], v[48:51]
    s_waitcnt lgkmcnt(5)
    ds_read_b128 v[156:159], v220 offset:18432
    s_mul_i32 s48, s55, 196608
    v_mfma_f32_16x16x32_bf16 v[52:55], v[208:211], v[132:135], v[52:55]
    ds_read_b128 v[160:163], v220 offset:20480
    v_add_u32 v10, s48, v11
    v_mfma_f32_16x16x32_bf16 v[56:59], v[212:215], v[132:135], v[56:59]
    s_waitcnt lgkmcnt(6)
    buffer_load_dwordx4 v18, s[4:7], s78 offen offset:1024 lds
    v_mfma_f32_16x16x32_bf16 v[60:63], v[208:211], v[136:139], v[60:63]
    ds_read_b128 v[164:167], v220 offset:22528
    v_min_u32 v4, 3, v1
    v_mfma_f32_16x16x32_bf16 v[64:67], v[212:215], v[136:139], v[64:67]
    s_waitcnt lgkmcnt(6)
    ds_read_b128 v[168:171], v220 offset:24576
    v_mul_u32_u24 v12, 4, v4
    v_mfma_f32_16x16x32_bf16 v[68:71], v[208:211], v[140:143], v[68:71]
    ds_read_b64_tr_b16 v[176:177], v224 offset:8192
    s_lshl_b32 s71, s44, 9
    v_mfma_f32_16x16x32_bf16 v[72:75], v[212:215], v[140:143], v[72:75]
    s_waitcnt lgkmcnt(7)
    buffer_load_dwordx4 v19, s[4:7], s78 offen offset:2048 lds
    v_mfma_f32_16x16x32_bf16 v[76:79], v[208:211], v[144:147], v[76:79]
    ds_read_b64_tr_b16 v[178:179], v224 offset:8704
    s_add_u32 s71, s71, 196608
    v_mfma_f32_16x16x32_bf16 v[80:83], v[212:215], v[144:147], v[80:83]
    s_waitcnt lgkmcnt(7)
    ds_read_b64_tr_b16 v[180:181], v224 offset:10240
    v_min_u32 v4, 5, v1
    v_mfma_f32_16x16x32_bf16 v[84:87], v[208:211], v[148:151], v[84:87]
    ds_read_b64_tr_b16 v[182:183], v224 offset:10752
    v_mul_u32_u24 v13, 4, v4
    v_mfma_f32_16x16x32_bf16 v[88:91], v[212:215], v[148:151], v[88:91]
    s_waitcnt lgkmcnt(8)
    ds_read_b128 v[172:175], v221 offset:0
    s_add_u32 s47, s54, 0
    v_mfma_f32_16x16x32_bf16 v[92:95], v[208:211], v[152:155], v[92:95]
    buffer_load_dwordx4 v20, s[4:7], s78 offen offset:3072 lds
    v_mfma_f32_16x16x32_bf16 v[96:99], v[212:215], v[152:155], v[96:99]
    s_waitcnt lgkmcnt(8)
    ds_read_b128 v[132:135], v221 offset:2048
    s_add_u32 m0, s85, 47104
    v_mfma_f32_16x16x32_bf16 v[100:103], v[208:211], v[156:159], v[100:103]
    ds_read_b128 v[136:139], v221 offset:4096
    s_mul_i32 s48, s47, 205
    v_mfma_f32_16x16x32_bf16 v[104:107], v[212:215], v[156:159], v[104:107]
    s_waitcnt lgkmcnt(9)
    ds_read_b128 v[140:143], v221 offset:6144
    s_lshr_b32 s48, s48, 11
    v_mfma_f32_16x16x32_bf16 v[108:111], v[208:211], v[160:163], v[108:111]
    buffer_load_dwordx4 v21, s[4:7], s78 offen offset:0 lds
    v_mfma_f32_16x16x32_bf16 v[112:115], v[212:215], v[160:163], v[112:115]
    s_waitcnt lgkmcnt(9)
    ds_read_b128 v[144:147], v221 offset:8192
    s_mul_i32 s49, s48, 10
    v_mfma_f32_16x16x32_bf16 v[116:119], v[208:211], v[164:167], v[116:119]
    ds_read_b128 v[148:151], v221 offset:10240
    s_sub_u32 s49, s47, s49
    v_mfma_f32_16x16x32_bf16 v[120:123], v[212:215], v[164:167], v[120:123]
    s_waitcnt lgkmcnt(10)
    ds_read_b128 v[152:155], v221 offset:12288
    s_lshl_b32 s61, s49, 2
    v_mfma_f32_16x16x32_bf16 v[124:127], v[208:211], v[168:171], v[124:127]
    buffer_load_dwordx4 v22, s[4:7], s78 offen offset:1024 lds
    v_mfma_f32_16x16x32_bf16 v[128:131], v[212:215], v[168:171], v[128:131]
    s_waitcnt lgkmcnt(6)
    ds_read_b128 v[156:159], v221 offset:14336
    s_add_u32 s61, s61, s44
    v_mfma_f32_16x16x32_bf16 v[28:31], v[176:179], v[172:175], v[28:31]
    ds_read_b128 v[160:163], v221 offset:16384
    s_lshl_b32 s61, s61, 10
    v_mfma_f32_16x16x32_bf16 v[32:35], v[180:183], v[172:175], v[32:35]
    s_waitcnt lgkmcnt(7)
    ds_read_b128 v[164:167], v221 offset:18432
    s_mul_i32 s49, s49, 13
    v_mfma_f32_16x16x32_bf16 v[36:39], v[176:179], v[132:135], v[36:39]
    s_mov_b32 exec_hi, 0
    buffer_load_dwordx4 v23, s[4:7], s78 offen offset:2048 lds
    s_mov_b32 exec_hi, -1
    v_mfma_f32_16x16x32_bf16 v[40:43], v[180:183], v[132:135], v[40:43]
    s_waitcnt lgkmcnt(7)
    ds_read_b128 v[168:171], v221 offset:20480
    s_add_u32 s49, s49, s48
    v_mfma_f32_16x16x32_bf16 v[44:47], v[176:179], v[136:139], v[44:47]
    ds_read_b128 v[172:175], v221 offset:22528
    s_mul_i32 s57, s49, 49152
    v_mfma_f32_16x16x32_bf16 v[48:51], v[180:183], v[136:139], v[48:51]
    s_waitcnt lgkmcnt(8)
    s_mul_i32 s65, s49, 20480
    s_add_u32 s47, s54, 32
    v_mfma_f32_16x16x32_bf16 v[52:55], v[176:179], v[140:143], v[52:55]
    ds_read_b128 v[132:135], v221 offset:24576
    s_mul_i32 s48, s47, 205
    v_mfma_f32_16x16x32_bf16 v[56:59], v[180:183], v[140:143], v[56:59]
    s_waitcnt lgkmcnt(8)
    s_lshr_b32 s48, s48, 11
    s_mul_i32 s49, s48, 10
    v_mfma_f32_16x16x32_bf16 v[60:63], v[176:179], v[144:147], v[60:63]
    s_sub_u32 s49, s47, s49
    s_lshl_b32 s62, s49, 2
    v_mfma_f32_16x16x32_bf16 v[64:67], v[180:183], v[144:147], v[64:67]
    s_waitcnt lgkmcnt(7)
    s_add_u32 s62, s62, s44
    s_lshl_b32 s62, s62, 10
    v_mfma_f32_16x16x32_bf16 v[68:71], v[176:179], v[148:151], v[68:71]
    s_mul_i32 s49, s49, 13
    s_add_u32 s49, s49, s48
    v_mfma_f32_16x16x32_bf16 v[72:75], v[180:183], v[148:151], v[72:75]
    s_waitcnt lgkmcnt(6)
    s_mul_i32 s58, s49, 49152
    s_mul_i32 s66, s49, 20480
    v_mfma_f32_16x16x32_bf16 v[76:79], v[176:179], v[152:155], v[76:79]
    s_waitcnt vmcnt(11) lgkmcnt(0)
    s_barrier
    v_mfma_f32_16x16x32_bf16 v[80:83], v[180:183], v[152:155], v[80:83]
    ds_read_b64_tr_b16 v[184:185], v222 offset:0
    s_add_u32 m0, s86, 86016
    s_mul_i32 s84, s79, 1536
    v_mfma_f32_16x16x32_bf16 v[84:87], v[176:179], v[156:159], v[84:87]
    buffer_load_dwordx4 v24, s[8:11], s84 offen offset:0 lds
    v_mfma_f32_16x16x32_bf16 v[88:91], v[180:183], v[156:159], v[88:91]
    ds_read_b64_tr_b16 v[186:187], v222 offset:512
    s_add_u32 s47, s54, 64
    v_mfma_f32_16x16x32_bf16 v[92:95], v[176:179], v[160:163], v[92:95]
    ds_read_b64_tr_b16 v[188:189], v222 offset:2048
    s_mul_i32 s48, s47, 205
    v_mfma_f32_16x16x32_bf16 v[96:99], v[180:183], v[160:163], v[96:99]
    buffer_load_dwordx4 v25, s[8:11], s84 offen offset:1024 lds
    v_mfma_f32_16x16x32_bf16 v[100:103], v[176:179], v[164:167], v[100:103]
    ds_read_b64_tr_b16 v[190:191], v222 offset:2560
    s_lshr_b32 s48, s48, 11
    v_mfma_f32_16x16x32_bf16 v[104:107], v[180:183], v[164:167], v[104:107]
    ds_read_b128 v[136:139], v216 offset:0
    s_mul_i32 s49, s48, 10
    v_mfma_f32_16x16x32_bf16 v[108:111], v[176:179], v[168:171], v[108:111]
    ds_read_b128 v[140:143], v216 offset:2048
    s_sub_u32 s49, s47, s49
    v_mfma_f32_16x16x32_bf16 v[112:115], v[180:183], v[168:171], v[112:115]
    buffer_load_dwordx4 v24, s[12:15], s84 offen offset:2048 lds
    v_mfma_f32_16x16x32_bf16 v[116:119], v[176:179], v[172:175], v[116:119]
    ds_read_b128 v[144:147], v216 offset:4096
    s_lshl_b32 s63, s49, 2
    v_mfma_f32_16x16x32_bf16 v[120:123], v[180:183], v[172:175], v[120:123]
    ds_read_b128 v[148:151], v216 offset:6144
    s_add_u32 s63, s63, s44
    v_mfma_f32_16x16x32_bf16 v[124:127], v[176:179], v[132:135], v[124:127]
    ds_read_b128 v[152:155], v216 offset:8192
    s_lshl_b32 s63, s63, 10
    v_mfma_f32_16x16x32_bf16 v[128:131], v[180:183], v[132:135], v[128:131]
    s_waitcnt lgkmcnt(4)
    buffer_load_dwordx4 v25, s[12:15], s84 offen offset:3072 lds
    v_mfma_f32_16x16x32_bf16 v[28:31], v[184:187], v[136:139], v[28:31]
    ds_read_b128 v[156:159], v216 offset:10240
    s_add_u32 m0, s85, 86016
    v_mfma_f32_16x16x32_bf16 v[32:35], v[188:191], v[136:139], v[32:35]
    s_waitcnt lgkmcnt(4)
    ds_read_b128 v[160:163], v216 offset:12288
    s_mul_i32 s49, s49, 13
    v_mfma_f32_16x16x32_bf16 v[36:39], v[184:187], v[140:143], v[36:39]
    ds_read_b128 v[164:167], v216 offset:14336
    s_add_u32 s49, s49, s48
    v_mfma_f32_16x16x32_bf16 v[40:43], v[188:191], v[140:143], v[40:43]
    s_waitcnt lgkmcnt(5)
    buffer_load_dwordx4 v17, s[4:7], s79 offen offset:0 lds
    v_mfma_f32_16x16x32_bf16 v[44:47], v[184:187], v[144:147], v[44:47]
    ds_read_b128 v[168:171], v216 offset:16384
    s_mul_i32 s59, s49, 49152
    v_mfma_f32_16x16x32_bf16 v[48:51], v[188:191], v[144:147], v[48:51]
    s_waitcnt lgkmcnt(5)
    ds_read_b128 v[172:175], v216 offset:18432
    s_mul_i32 s67, s49, 20480
    v_mfma_f32_16x16x32_bf16 v[52:55], v[184:187], v[148:151], v[52:55]
    ds_read_b128 v[132:135], v216 offset:20480
    s_add_u32 s47, s54, 96
    v_mfma_f32_16x16x32_bf16 v[56:59], v[188:191], v[148:151], v[56:59]
    s_waitcnt lgkmcnt(6)
    buffer_load_dwordx4 v18, s[4:7], s79 offen offset:1024 lds
    v_mfma_f32_16x16x32_bf16 v[60:63], v[184:187], v[152:155], v[60:63]
    ds_read_b128 v[136:139], v216 offset:22528
    s_mul_i32 s48, s47, 205
    v_mfma_f32_16x16x32_bf16 v[64:67], v[188:191], v[152:155], v[64:67]
    s_waitcnt lgkmcnt(6)
    ds_read_b128 v[140:143], v216 offset:24576
    s_lshr_b32 s48, s48, 11
    v_mfma_f32_16x16x32_bf16 v[68:71], v[184:187], v[156:159], v[68:71]
    ds_read_b64_tr_b16 v[192:193], v222 offset:8192
    s_mul_i32 s49, s48, 10
    v_mfma_f32_16x16x32_bf16 v[72:75], v[188:191], v[156:159], v[72:75]
    s_waitcnt lgkmcnt(7)
    buffer_load_dwordx4 v19, s[4:7], s79 offen offset:2048 lds
    v_mfma_f32_16x16x32_bf16 v[76:79], v[184:187], v[160:163], v[76:79]
    ds_read_b64_tr_b16 v[194:195], v222 offset:8704
    s_sub_u32 s49, s47, s49
    v_mfma_f32_16x16x32_bf16 v[80:83], v[188:191], v[160:163], v[80:83]
    s_waitcnt lgkmcnt(7)
    ds_read_b64_tr_b16 v[196:197], v222 offset:10240
    s_cmp_ge_u32 s47, 119
    s_cselect_b32 s60, 12, 11
    s_cselect_b32 s68, 9, 0
    v_mfma_f32_16x16x32_bf16 v[84:87], v[184:187], v[164:167], v[84:87]
    ds_read_b64_tr_b16 v[198:199], v222 offset:10752
    s_sub_u32 s68, s47, s68
    v_mfma_f32_16x16x32_bf16 v[88:91], v[188:191], v[164:167], v[88:91]
    s_waitcnt lgkmcnt(8)
    buffer_load_dwordx4 v20, s[4:7], s79 offen offset:3072 lds
    v_mfma_f32_16x16x32_bf16 v[92:95], v[184:187], v[168:171], v[92:95]
    ds_read_b128 v[144:147], v217 offset:0
    s_add_u32 m0, s85, 90112
    v_mfma_f32_16x16x32_bf16 v[96:99], v[188:191], v[168:171], v[96:99]
    s_waitcnt lgkmcnt(8)
    ds_read_b128 v[148:151], v217 offset:2048
    s_sub_u32 s68, s68, 110
    v_mfma_f32_16x16x32_bf16 v[100:103], v[184:187], v[172:175], v[100:103]
    ds_read_b128 v[152:155], v217 offset:4096
    s_cmp_ge_u32 s47, 110
    s_cselect_b32 s48, s60, s48
    s_cselect_b32 s49, s68, s49
    v_mfma_f32_16x16x32_bf16 v[104:107], v[188:191], v[172:175], v[104:107]
    s_waitcnt lgkmcnt(9)
    buffer_load_dwordx4 v21, s[4:7], s79 offen offset:0 lds
    v_mfma_f32_16x16x32_bf16 v[108:111], v[184:187], v[132:135], v[108:111]
    ds_read_b128 v[156:159], v217 offset:6144
    s_lshl_b32 s64, s49, 2
    v_mfma_f32_16x16x32_bf16 v[112:115], v[188:191], v[132:135], v[112:115]
    s_waitcnt lgkmcnt(9)
    ds_read_b128 v[160:163], v217 offset:8192
    s_add_u32 s64, s64, s44
    v_mfma_f32_16x16x32_bf16 v[116:119], v[184:187], v[136:139], v[116:119]
    ds_read_b128 v[164:167], v217 offset:10240
    s_lshl_b32 s64, s64, 10
    v_mfma_f32_16x16x32_bf16 v[120:123], v[188:191], v[136:139], v[120:123]
    s_waitcnt lgkmcnt(10)
    buffer_load_dwordx4 v22, s[4:7], s79 offen offset:1024 lds
    v_mfma_f32_16x16x32_bf16 v[124:127], v[184:187], v[140:143], v[124:127]
    ds_read_b128 v[168:171], v217 offset:12288
    s_mul_i32 s49, s49, 13
    v_mfma_f32_16x16x32_bf16 v[128:131], v[188:191], v[140:143], v[128:131]
    s_waitcnt lgkmcnt(6)
    ds_read_b128 v[172:175], v217 offset:14336
    s_add_u32 s49, s49, s48
    v_mfma_f32_16x16x32_bf16 v[28:31], v[192:195], v[144:147], v[28:31]
    ds_read_b128 v[132:135], v217 offset:16384
    s_mul_i32 s60, s49, 49152
    v_mfma_f32_16x16x32_bf16 v[32:35], v[196:199], v[144:147], v[32:35]
    s_waitcnt lgkmcnt(7)
    s_mov_b32 exec_hi, 0
    buffer_load_dwordx4 v23, s[4:7], s79 offen offset:2048 lds
    s_mov_b32 exec_hi, -1
    v_mfma_f32_16x16x32_bf16 v[36:39], v[192:195], v[148:151], v[36:39]
    ds_read_b128 v[136:139], v217 offset:18432
    s_mul_i32 s68, s49, 20480
    v_mfma_f32_16x16x32_bf16 v[40:43], v[196:199], v[148:151], v[40:43]
    s_waitcnt lgkmcnt(7)
    ds_read_b128 v[140:143], v217 offset:20480
    v_lshrrev_b32 v4, 4, v1
    v_mfma_f32_16x16x32_bf16 v[44:47], v[192:195], v[152:155], v[44:47]
    ds_read_b128 v[144:147], v217 offset:22528
    v_and_b32 v5, 15, v1
    v_mfma_f32_16x16x32_bf16 v[48:51], v[196:199], v[152:155], v[48:51]
    s_waitcnt lgkmcnt(8)
    v_mul_u32_u24 v5, 336, v5
    v_lshl_add_u32 v4, v4, 4, v5
    v_mfma_f32_16x16x32_bf16 v[52:55], v[192:195], v[156:159], v[52:55]
    ds_read_b128 v[148:151], v217 offset:24576
    s_mul_i32 s47, s44, 5376
    v_mfma_f32_16x16x32_bf16 v[56:59], v[196:199], v[156:159], v[56:59]
    s_waitcnt lgkmcnt(8)
    v_add_u32 v14, s47, v4
    v_min_u32 v4, 39, v1
    v_mfma_f32_16x16x32_bf16 v[60:63], v[192:195], v[160:163], v[60:63]
    v_mul_u32_u24 v5, 26, v4
    v_lshrrev_b32 v5, 8, v5
    v_mfma_f32_16x16x32_bf16 v[64:67], v[196:199], v[160:163], v[64:67]
    s_waitcnt lgkmcnt(7)
    v_mul_u32_u24 v6, 10, v5
    v_sub_u32 v4, v4, v6
    v_mfma_f32_16x16x32_bf16 v[68:71], v[192:195], v[164:167], v[68:71]
    s_lshl_b32 s47, s44, 2
    v_add_u32 v5, s47, v5
    v_mfma_f32_16x16x32_bf16 v[72:75], v[196:199], v[164:167], v[72:75]
    s_waitcnt lgkmcnt(6)
    v_mul_u32_u24 v15, 336, v5
    v_lshl_add_u32 v15, v4, 5, v15
    v_mfma_f32_16x16x32_bf16 v[76:79], v[192:195], v[168:171], v[76:79]
    s_waitcnt vmcnt(11) lgkmcnt(0)
    s_barrier
    v_mfma_f32_16x16x32_bf16 v[80:83], v[196:199], v[168:171], v[80:83]
    ds_read_b64_tr_b16 v[200:201], v223 offset:0
    s_add_u32 m0, s86, 0
    s_mul_i32 s84, s80, 1536
    v_mfma_f32_16x16x32_bf16 v[84:87], v[192:195], v[172:175], v[84:87]
    buffer_load_dwordx4 v24, s[8:11], s84 offen offset:0 lds
    v_mfma_f32_16x16x32_bf16 v[88:91], v[196:199], v[172:175], v[88:91]
    ds_read_b64_tr_b16 v[202:203], v223 offset:512
    v_mul_u32_u24 v5, 1280, v5
    v_mfma_f32_16x16x32_bf16 v[92:95], v[192:195], v[132:135], v[92:95]
    ds_read_b64_tr_b16 v[204:205], v223 offset:2048
    v_lshl_add_u32 v5, v4, 4, v5
    v_mfma_f32_16x16x32_bf16 v[96:99], v[196:199], v[132:135], v[96:99]
    buffer_load_dwordx4 v25, s[8:11], s84 offen offset:1024 lds
    v_mfma_f32_16x16x32_bf16 v[100:103], v[192:195], v[136:139], v[100:103]
    ds_read_b64_tr_b16 v[206:207], v223 offset:2560
    s_lshl_b32 s47, s55, 7
    v_mfma_f32_16x16x32_bf16 v[104:107], v[196:199], v[136:139], v[104:107]
    ds_read_b128 v[152:155], v218 offset:0
    s_lshl_b32 s48, s55, 5
    v_mfma_f32_16x16x32_bf16 v[108:111], v[192:195], v[140:143], v[108:111]
    ds_read_b128 v[156:159], v218 offset:2048
    s_add_u32 s48, s48, 896
    v_mfma_f32_16x16x32_bf16 v[112:115], v[196:199], v[140:143], v[112:115]
    buffer_load_dwordx4 v24, s[12:15], s84 offen offset:2048 lds
    v_mfma_f32_16x16x32_bf16 v[116:119], v[192:195], v[144:147], v[116:119]
    ds_read_b128 v[160:163], v218 offset:4096
    v_mov_b32 v6, s47
    v_mfma_f32_16x16x32_bf16 v[120:123], v[196:199], v[144:147], v[120:123]
    ds_read_b128 v[164:167], v218 offset:6144
    v_mov_b32 v7, s48
    v_mfma_f32_16x16x32_bf16 v[124:127], v[192:195], v[148:151], v[124:127]
    ds_read_b128 v[168:171], v218 offset:8192
    v_cmp_lt_u32 vcc, 7, v4
    s_nop 1
    v_cndmask_b32 v6, v6, v7, vcc
    v_mfma_f32_16x16x32_bf16 v[128:131], v[196:199], v[148:151], v[128:131]
    s_waitcnt lgkmcnt(4)
    buffer_load_dwordx4 v25, s[12:15], s84 offen offset:3072 lds
    v_mfma_f32_16x16x32_bf16 v[28:31], v[200:203], v[152:155], v[28:31]
    ds_read_b128 v[172:175], v218 offset:10240
    s_add_u32 m0, s85, 0
    v_mfma_f32_16x16x32_bf16 v[32:35], v[204:207], v[152:155], v[32:35]
    s_waitcnt lgkmcnt(4)
    ds_read_b128 v[132:135], v218 offset:12288
    v_add_u32 v16, v5, v6
    v_mfma_f32_16x16x32_bf16 v[36:39], v[200:203], v[156:159], v[36:39]
    ds_read_b128 v[136:139], v218 offset:14336
    s_mul_i32 s70, s55, -147456
    v_mfma_f32_16x16x32_bf16 v[40:43], v[204:207], v[156:159], v[40:43]
    s_waitcnt lgkmcnt(5)
    buffer_load_dwordx4 v17, s[4:7], s80 offen offset:0 lds
    v_mfma_f32_16x16x32_bf16 v[44:47], v[200:203], v[160:163], v[44:47]
    ds_read_b128 v[140:143], v218 offset:16384
    s_add_u32 s70, s70, 1572864
    v_mfma_f32_16x16x32_bf16 v[48:51], v[204:207], v[160:163], v[48:51]
    s_waitcnt lgkmcnt(5)
    ds_read_b128 v[144:147], v218 offset:18432
    v_mfma_f32_16x16x32_bf16 v[52:55], v[200:203], v[164:167], v[52:55]
    ds_read_b128 v[148:151], v218 offset:20480
    v_mfma_f32_16x16x32_bf16 v[56:59], v[204:207], v[164:167], v[56:59]
    s_waitcnt lgkmcnt(6)
    buffer_load_dwordx4 v18, s[4:7], s80 offen offset:1024 lds
    v_mfma_f32_16x16x32_bf16 v[60:63], v[200:203], v[168:171], v[60:63]
    ds_read_b128 v[152:155], v218 offset:22528
    v_mfma_f32_16x16x32_bf16 v[64:67], v[204:207], v[168:171], v[64:67]
    s_waitcnt lgkmcnt(6)
    ds_read_b128 v[156:159], v218 offset:24576
    v_mfma_f32_16x16x32_bf16 v[68:71], v[200:203], v[172:175], v[68:71]
    ds_read_b64_tr_b16 v[208:209], v223 offset:8192
    v_mfma_f32_16x16x32_bf16 v[72:75], v[204:207], v[172:175], v[72:75]
    s_waitcnt lgkmcnt(7)
    buffer_load_dwordx4 v19, s[4:7], s80 offen offset:2048 lds
    v_mfma_f32_16x16x32_bf16 v[76:79], v[200:203], v[132:135], v[76:79]
    ds_read_b64_tr_b16 v[210:211], v223 offset:8704
    v_mfma_f32_16x16x32_bf16 v[80:83], v[204:207], v[132:135], v[80:83]
    s_waitcnt lgkmcnt(7)
    ds_read_b64_tr_b16 v[212:213], v223 offset:10240
    v_mfma_f32_16x16x32_bf16 v[84:87], v[200:203], v[136:139], v[84:87]
    ds_read_b64_tr_b16 v[214:215], v223 offset:10752
    v_mfma_f32_16x16x32_bf16 v[88:91], v[204:207], v[136:139], v[88:91]
    s_waitcnt lgkmcnt(8)
    buffer_load_dwordx4 v20, s[4:7], s80 offen offset:3072 lds
    v_mfma_f32_16x16x32_bf16 v[92:95], v[200:203], v[140:143], v[92:95]
    ds_read_b128 v[160:163], v219 offset:0
    s_add_u32 m0, s85, 4096
    v_mfma_f32_16x16x32_bf16 v[96:99], v[204:207], v[140:143], v[96:99]
    s_waitcnt lgkmcnt(8)
    ds_read_b128 v[164:167], v219 offset:2048
    v_mfma_f32_16x16x32_bf16 v[100:103], v[200:203], v[144:147], v[100:103]
    ds_read_b128 v[168:171], v219 offset:4096
    v_mfma_f32_16x16x32_bf16 v[104:107], v[204:207], v[144:147], v[104:107]
    s_waitcnt lgkmcnt(9)
    ds_read_b128 v[172:175], v219 offset:6144
    v_mfma_f32_16x16x32_bf16 v[108:111], v[200:203], v[148:151], v[108:111]
    buffer_load_dwordx4 v21, s[4:7], s80 offen offset:0 lds
    v_mfma_f32_16x16x32_bf16 v[112:115], v[204:207], v[148:151], v[112:115]
    s_waitcnt lgkmcnt(9)
    ds_read_b128 v[132:135], v219 offset:8192
    v_mfma_f32_16x16x32_bf16 v[116:119], v[200:203], v[152:155], v[116:119]
    ds_read_b128 v[136:139], v219 offset:10240
    v_mfma_f32_16x16x32_bf16 v[120:123], v[204:207], v[152:155], v[120:123]
    s_waitcnt lgkmcnt(10)
    ds_read_b128 v[140:143], v219 offset:12288
    v_mfma_f32_16x16x32_bf16 v[124:127], v[200:203], v[156:159], v[124:127]
    buffer_load_dwordx4 v22, s[4:7], s80 offen offset:1024 lds
    v_mfma_f32_16x16x32_bf16 v[128:131], v[204:207], v[156:159], v[128:131]
    s_waitcnt lgkmcnt(6)
    ds_read_b128 v[144:147], v219 offset:14336
    v_mfma_f32_16x16x32_bf16 v[28:31], v[208:211], v[160:163], v[28:31]
    ds_read_b128 v[148:151], v219 offset:16384
    v_mfma_f32_16x16x32_bf16 v[32:35], v[212:215], v[160:163], v[32:35]
    s_waitcnt lgkmcnt(7)
    ds_read_b128 v[152:155], v219 offset:18432
    v_mfma_f32_16x16x32_bf16 v[36:39], v[208:211], v[164:167], v[36:39]
    s_mov_b32 exec_hi, 0
    buffer_load_dwordx4 v23, s[4:7], s80 offen offset:2048 lds
    s_mov_b32 exec_hi, -1
    v_mfma_f32_16x16x32_bf16 v[40:43], v[212:215], v[164:167], v[40:43]
    s_waitcnt lgkmcnt(7)
    ds_read_b128 v[156:159], v219 offset:20480
    v_mfma_f32_16x16x32_bf16 v[44:47], v[208:211], v[168:171], v[44:47]
    ds_read_b128 v[160:163], v219 offset:22528
    v_mfma_f32_16x16x32_bf16 v[48:51], v[212:215], v[168:171], v[48:51]
    s_waitcnt lgkmcnt(8)
    v_mfma_f32_16x16x32_bf16 v[52:55], v[208:211], v[172:175], v[52:55]
    ds_read_b128 v[164:167], v219 offset:24576
    v_mfma_f32_16x16x32_bf16 v[56:59], v[212:215], v[172:175], v[56:59]
    s_waitcnt lgkmcnt(8)
    v_mfma_f32_16x16x32_bf16 v[60:63], v[208:211], v[132:135], v[60:63]
    v_mfma_f32_16x16x32_bf16 v[64:67], v[212:215], v[132:135], v[64:67]
    s_waitcnt lgkmcnt(7)
    v_mfma_f32_16x16x32_bf16 v[68:71], v[208:211], v[136:139], v[68:71]
    v_mfma_f32_16x16x32_bf16 v[72:75], v[212:215], v[136:139], v[72:75]
    s_waitcnt lgkmcnt(6)
    v_mfma_f32_16x16x32_bf16 v[76:79], v[208:211], v[140:143], v[76:79]
    s_waitcnt vmcnt(11) lgkmcnt(0)
    s_barrier
    s_buffer_load_dword s52, s[32:35], 0
    v_mfma_f32_16x16x32_bf16 v[80:83], v[212:215], v[140:143], v[80:83]
    ds_read_b64_tr_b16 v[176:177], v224 offset:0
    s_add_u32 m0, s86, 43008
    s_mul_i32 s84, s81, 1536
    v_mfma_f32_16x16x32_bf16 v[84:87], v[208:211], v[144:147], v[84:87]
    buffer_load_dwordx4 v24, s[8:11], s84 offen offset:0 lds
    v_mfma_f32_16x16x32_bf16 v[88:91], v[212:215], v[144:147], v[88:91]
    ds_read_b64_tr_b16 v[178:179], v224 offset:512
    v_mfma_f32_16x16x32_bf16 v[92:95], v[208:211], v[148:151], v[92:95]
    ds_read_b64_tr_b16 v[180:181], v224 offset:2048
    v_mfma_f32_16x16x32_bf16 v[96:99], v[212:215], v[148:151], v[96:99]
    buffer_load_dwordx4 v25, s[8:11], s84 offen offset:1024 lds
    v_mfma_f32_16x16x32_bf16 v[100:103], v[208:211], v[152:155], v[100:103]
    ds_read_b64_tr_b16 v[182:183], v224 offset:2560
    v_mfma_f32_16x16x32_bf16 v[104:107], v[212:215], v[152:155], v[104:107]
    ds_read_b128 v[168:171], v220 offset:0
    v_mfma_f32_16x16x32_bf16 v[108:111], v[208:211], v[156:159], v[108:111]
    ds_read_b128 v[172:175], v220 offset:2048
    v_mfma_f32_16x16x32_bf16 v[112:115], v[212:215], v[156:159], v[112:115]
    buffer_load_dwordx4 v24, s[12:15], s84 offen offset:2048 lds
    v_mfma_f32_16x16x32_bf16 v[116:119], v[208:211], v[160:163], v[116:119]
    ds_read_b128 v[132:135], v220 offset:4096
    v_mfma_f32_16x16x32_bf16 v[120:123], v[212:215], v[160:163], v[120:123]
    ds_read_b128 v[136:139], v220 offset:6144
    v_mfma_f32_16x16x32_bf16 v[124:127], v[208:211], v[164:167], v[124:127]
    ds_read_b128 v[140:143], v220 offset:8192
    v_mfma_f32_16x16x32_bf16 v[128:131], v[212:215], v[164:167], v[128:131]
    s_waitcnt lgkmcnt(4)
    buffer_load_dwordx4 v25, s[12:15], s84 offen offset:3072 lds
    v_mfma_f32_16x16x32_bf16 v[28:31], v[176:179], v[168:171], v[28:31]
    ds_read_b128 v[144:147], v220 offset:10240
    s_add_u32 m0, s85, 43008
    v_mfma_f32_16x16x32_bf16 v[32:35], v[180:183], v[168:171], v[32:35]
    s_waitcnt lgkmcnt(4)
    ds_read_b128 v[148:151], v220 offset:12288
    v_mfma_f32_16x16x32_bf16 v[36:39], v[176:179], v[172:175], v[36:39]
    ds_read_b128 v[152:155], v220 offset:14336
    v_mfma_f32_16x16x32_bf16 v[40:43], v[180:183], v[172:175], v[40:43]
    s_waitcnt lgkmcnt(5)
    buffer_load_dwordx4 v17, s[4:7], s81 offen offset:0 lds
    v_mfma_f32_16x16x32_bf16 v[44:47], v[176:179], v[132:135], v[44:47]
    ds_read_b128 v[156:159], v220 offset:16384
    v_mfma_f32_16x16x32_bf16 v[48:51], v[180:183], v[132:135], v[48:51]
    s_waitcnt lgkmcnt(5)
    ds_read_b128 v[160:163], v220 offset:18432
    v_mfma_f32_16x16x32_bf16 v[52:55], v[176:179], v[136:139], v[52:55]
    ds_read_b128 v[164:167], v220 offset:20480
    v_mfma_f32_16x16x32_bf16 v[56:59], v[180:183], v[136:139], v[56:59]
    s_waitcnt lgkmcnt(6)
    buffer_load_dwordx4 v18, s[4:7], s81 offen offset:1024 lds
    v_mfma_f32_16x16x32_bf16 v[60:63], v[176:179], v[140:143], v[60:63]
    ds_read_b128 v[168:171], v220 offset:22528
    v_mfma_f32_16x16x32_bf16 v[64:67], v[180:183], v[140:143], v[64:67]
    s_waitcnt lgkmcnt(6)
    ds_read_b128 v[172:175], v220 offset:24576
    v_mfma_f32_16x16x32_bf16 v[68:71], v[176:179], v[144:147], v[68:71]
    ds_read_b64_tr_b16 v[184:185], v224 offset:8192
    v_mfma_f32_16x16x32_bf16 v[72:75], v[180:183], v[144:147], v[72:75]
    s_waitcnt lgkmcnt(7)
    buffer_load_dwordx4 v19, s[4:7], s81 offen offset:2048 lds
    v_mfma_f32_16x16x32_bf16 v[76:79], v[176:179], v[148:151], v[76:79]
    ds_read_b64_tr_b16 v[186:187], v224 offset:8704
    v_mfma_f32_16x16x32_bf16 v[80:83], v[180:183], v[148:151], v[80:83]
    s_waitcnt lgkmcnt(7)
    ds_read_b64_tr_b16 v[188:189], v224 offset:10240
    v_mfma_f32_16x16x32_bf16 v[84:87], v[176:179], v[152:155], v[84:87]
    ds_read_b64_tr_b16 v[190:191], v224 offset:10752
    v_mfma_f32_16x16x32_bf16 v[88:91], v[180:183], v[152:155], v[88:91]
    s_waitcnt lgkmcnt(8)
    ds_read_b128 v[132:135], v221 offset:0
    v_mfma_f32_16x16x32_bf16 v[92:95], v[176:179], v[156:159], v[92:95]
    buffer_load_dwordx4 v20, s[4:7], s81 offen offset:3072 lds
    v_mfma_f32_16x16x32_bf16 v[96:99], v[180:183], v[156:159], v[96:99]
    s_waitcnt lgkmcnt(8)
    ds_read_b128 v[136:139], v221 offset:2048
    s_add_u32 m0, s85, 47104
    v_mfma_f32_16x16x32_bf16 v[100:103], v[176:179], v[160:163], v[100:103]
    ds_read_b128 v[140:143], v221 offset:4096
    v_mfma_f32_16x16x32_bf16 v[104:107], v[180:183], v[160:163], v[104:107]
    s_waitcnt lgkmcnt(9)
    ds_read_b128 v[144:147], v221 offset:6144
    v_mfma_f32_16x16x32_bf16 v[108:111], v[176:179], v[164:167], v[108:111]
    buffer_load_dwordx4 v21, s[4:7], s81 offen offset:0 lds
    v_mfma_f32_16x16x32_bf16 v[112:115], v[180:183], v[164:167], v[112:115]
    s_waitcnt lgkmcnt(9)
    ds_read_b128 v[148:151], v221 offset:8192
    v_mfma_f32_16x16x32_bf16 v[116:119], v[176:179], v[168:171], v[116:119]
    ds_read_b128 v[152:155], v221 offset:10240
    v_mfma_f32_16x16x32_bf16 v[120:123], v[180:183], v[168:171], v[120:123]
    s_waitcnt lgkmcnt(10)
    ds_read_b128 v[156:159], v221 offset:12288
    v_mfma_f32_16x16x32_bf16 v[124:127], v[176:179], v[172:175], v[124:127]
    buffer_load_dwordx4 v22, s[4:7], s81 offen offset:1024 lds
    v_mfma_f32_16x16x32_bf16 v[128:131], v[180:183], v[172:175], v[128:131]
    s_waitcnt lgkmcnt(6)
    ds_read_b128 v[160:163], v221 offset:14336
    v_mfma_f32_16x16x32_bf16 v[28:31], v[184:187], v[132:135], v[28:31]
    ds_read_b128 v[164:167], v221 offset:16384
    v_mfma_f32_16x16x32_bf16 v[32:35], v[188:191], v[132:135], v[32:35]
    s_waitcnt lgkmcnt(7)
    ds_read_b128 v[168:171], v221 offset:18432
    v_mfma_f32_16x16x32_bf16 v[36:39], v[184:187], v[136:139], v[36:39]
    s_mov_b32 exec_hi, 0
    buffer_load_dwordx4 v23, s[4:7], s81 offen offset:2048 lds
    s_mov_b32 exec_hi, -1
    v_mfma_f32_16x16x32_bf16 v[40:43], v[188:191], v[136:139], v[40:43]
    s_waitcnt lgkmcnt(7)
    ds_read_b128 v[172:175], v221 offset:20480
    v_mfma_f32_16x16x32_bf16 v[44:47], v[184:187], v[140:143], v[44:47]
    ds_read_b128 v[132:135], v221 offset:22528
    v_mfma_f32_16x16x32_bf16 v[48:51], v[188:191], v[140:143], v[48:51]
    s_waitcnt lgkmcnt(8)
    v_mfma_f32_16x16x32_bf16 v[52:55], v[184:187], v[144:147], v[52:55]
    ds_read_b128 v[136:139], v221 offset:24576
    v_mfma_f32_16x16x32_bf16 v[56:59], v[188:191], v[144:147], v[56:59]
    s_waitcnt lgkmcnt(8)
    v_mfma_f32_16x16x32_bf16 v[60:63], v[184:187], v[148:151], v[60:63]
    v_mfma_f32_16x16x32_bf16 v[64:67], v[188:191], v[148:151], v[64:67]
    s_waitcnt lgkmcnt(7)
    v_mfma_f32_16x16x32_bf16 v[68:71], v[184:187], v[152:155], v[68:71]
    v_mfma_f32_16x16x32_bf16 v[72:75], v[188:191], v[152:155], v[72:75]
    s_waitcnt lgkmcnt(6)
    v_mfma_f32_16x16x32_bf16 v[76:79], v[184:187], v[156:159], v[76:79]
    s_waitcnt vmcnt(11) lgkmcnt(0)
    s_barrier
    s_cmp_eq_u32 s52, 0
    s_cbranch_scc1 L_tok_slow
L_tok_ok:
    v_mov_b32 v8, s52
    s_mov_b32 s53, s52
    v_mfma_f32_16x16x32_bf16 v[80:83], v[188:191], v[156:159], v[80:83]
    ds_read_b64_tr_b16 v[192:193], v222 offset:0
    s_add_u32 m0, s86, 86016
    s_mul_i32 s84, s82, 1536
    v_mfma_f32_16x16x32_bf16 v[84:87], v[184:187], v[160:163], v[84:87]
    buffer_load_dwordx4 v24, s[8:11], s84 offen offset:0 lds
    v_mfma_f32_16x16x32_bf16 v[88:91], v[188:191], v[160:163], v[88:91]
    ds_read_b64_tr_b16 v[194:195], v222 offset:512
    v_mfma_f32_16x16x32_bf16 v[92:95], v[184:187], v[164:167], v[92:95]
    ds_read_b64_tr_b16 v[196:197], v222 offset:2048
    v_mfma_f32_16x16x32_bf16 v[96:99], v[188:191], v[164:167], v[96:99]
    buffer_load_dwordx4 v25, s[8:11], s84 offen offset:1024 lds
    v_mfma_f32_16x16x32_bf16 v[100:103], v[184:187], v[168:171], v[100:103]
    ds_read_b64_tr_b16 v[198:199], v222 offset:2560
    v_mfma_f32_16x16x32_bf16 v[104:107], v[188:191], v[168:171], v[104:107]
    ds_read_b128 v[140:143], v216 offset:0
    v_mfma_f32_16x16x32_bf16 v[108:111], v[184:187], v[172:175], v[108:111]
    ds_read_b128 v[144:147], v216 offset:2048
    v_mfma_f32_16x16x32_bf16 v[112:115], v[188:191], v[172:175], v[112:115]
    buffer_load_dwordx4 v24, s[12:15], s84 offen offset:2048 lds
    v_mfma_f32_16x16x32_bf16 v[116:119], v[184:187], v[132:135], v[116:119]
    ds_read_b128 v[148:151], v216 offset:4096
    v_mfma_f32_16x16x32_bf16 v[120:123], v[188:191], v[132:135], v[120:123]
    ds_read_b128 v[152:155], v216 offset:6144
    v_mfma_f32_16x16x32_bf16 v[124:127], v[184:187], v[136:139], v[124:127]
    ds_read_b128 v[156:159], v216 offset:8192
    v_mfma_f32_16x16x32_bf16 v[128:131], v[188:191], v[136:139], v[128:131]
    s_waitcnt lgkmcnt(4)
    buffer_load_dwordx4 v25, s[12:15], s84 offen offset:3072 lds
    v_mfma_f32_16x16x32_bf16 v[28:31], v[192:195], v[140:143], v[28:31]
    ds_read_b128 v[160:163], v216 offset:10240
    s_add_u32 m0, s85, 86016
    v_mfma_f32_16x16x32_bf16 v[32:35], v[196:199], v[140:143], v[32:35]
    s_waitcnt lgkmcnt(4)
    ds_read_b128 v[164:167], v216 offset:12288
    v_mfma_f32_16x16x32_bf16 v[36:39], v[192:195], v[144:147], v[36:39]
    ds_read_b128 v[168:171], v216 offset:14336
    v_mfma_f32_16x16x32_bf16 v[40:43], v[196:199], v[144:147], v[40:43]
    s_waitcnt lgkmcnt(5)
    buffer_load_dwordx4 v17, s[4:7], s82 offen offset:0 lds
    v_mfma_f32_16x16x32_bf16 v[44:47], v[192:195], v[148:151], v[44:47]
    ds_read_b128 v[172:175], v216 offset:16384
    v_mfma_f32_16x16x32_bf16 v[48:51], v[196:199], v[148:151], v[48:51]
    s_waitcnt lgkmcnt(5)
    ds_read_b128 v[132:135], v216 offset:18432
    v_mfma_f32_16x16x32_bf16 v[52:55], v[192:195], v[152:155], v[52:55]
    ds_read_b128 v[136:139], v216 offset:20480
    v_mfma_f32_16x16x32_bf16 v[56:59], v[196:199], v[152:155], v[56:59]
    s_waitcnt lgkmcnt(6)
    buffer_load_dwordx4 v18, s[4:7], s82 offen offset:1024 lds
    v_mfma_f32_16x16x32_bf16 v[60:63], v[192:195], v[156:159], v[60:63]
    ds_read_b128 v[140:143], v216 offset:22528
    v_mfma_f32_16x16x32_bf16 v[64:67], v[196:199], v[156:159], v[64:67]
    s_waitcnt lgkmcnt(6)
    ds_read_b128 v[144:147], v216 offset:24576
    v_mfma_f32_16x16x32_bf16 v[68:71], v[192:195], v[160:163], v[68:71]
    ds_read_b64_tr_b16 v[200:201], v222 offset:8192
    v_mfma_f32_16x16x32_bf16 v[72:75], v[196:199], v[160:163], v[72:75]
    s_waitcnt lgkmcnt(7)
    buffer_load_dwordx4 v19, s[4:7], s82 offen offset:2048 lds
    v_mfma_f32_16x16x32_bf16 v[76:79], v[192:195], v[164:167], v[76:79]
    ds_read_b64_tr_b16 v[202:203], v222 offset:8704
    v_mfma_f32_16x16x32_bf16 v[80:83], v[196:199], v[164:167], v[80:83]
    s_waitcnt lgkmcnt(7)
    ds_read_b64_tr_b16 v[204:205], v222 offset:10240
    v_mfma_f32_16x16x32_bf16 v[84:87], v[192:195], v[168:171], v[84:87]
    ds_read_b64_tr_b16 v[206:207], v222 offset:10752
    v_mfma_f32_16x16x32_bf16 v[88:91], v[196:199], v[168:171], v[88:91]
    s_waitcnt lgkmcnt(8)
    ds_read_b128 v[148:151], v217 offset:0
    v_mfma_f32_16x16x32_bf16 v[92:95], v[192:195], v[172:175], v[92:95]
    buffer_load_dwordx4 v20, s[4:7], s82 offen offset:3072 lds
    v_mfma_f32_16x16x32_bf16 v[96:99], v[196:199], v[172:175], v[96:99]
    s_waitcnt lgkmcnt(8)
    ds_read_b128 v[152:155], v217 offset:2048
    s_add_u32 m0, s85, 90112
    v_mfma_f32_16x16x32_bf16 v[100:103], v[192:195], v[132:135], v[100:103]
    ds_read_b128 v[156:159], v217 offset:4096
    v_mfma_f32_16x16x32_bf16 v[104:107], v[196:199], v[132:135], v[104:107]
    s_waitcnt lgkmcnt(9)
    ds_read_b128 v[160:163], v217 offset:6144
    v_mfma_f32_16x16x32_bf16 v[108:111], v[192:195], v[136:139], v[108:111]
    buffer_load_dwordx4 v21, s[4:7], s82 offen offset:0 lds
    v_mfma_f32_16x16x32_bf16 v[112:115], v[196:199], v[136:139], v[112:115]
    s_waitcnt lgkmcnt(9)
    ds_read_b128 v[164:167], v217 offset:8192
    v_mfma_f32_16x16x32_bf16 v[116:119], v[192:195], v[140:143], v[116:119]
    ds_read_b128 v[168:171], v217 offset:10240
    v_mfma_f32_16x16x32_bf16 v[120:123], v[196:199], v[140:143], v[120:123]
    s_waitcnt lgkmcnt(10)
    ds_read_b128 v[172:175], v217 offset:12288
    v_mfma_f32_16x16x32_bf16 v[124:127], v[192:195], v[144:147], v[124:127]
    buffer_load_dwordx4 v22, s[4:7], s82 offen offset:1024 lds
    v_mfma_f32_16x16x32_bf16 v[128:131], v[196:199], v[144:147], v[128:131]
    s_waitcnt lgkmcnt(6)
    ds_read_b128 v[132:135], v217 offset:14336
    v_mfma_f32_16x16x32_bf16 v[28:31], v[200:203], v[148:151], v[28:31]
    ds_read_b128 v[136:139], v217 offset:16384
    v_mfma_f32_16x16x32_bf16 v[32:35], v[204:207], v[148:151], v[32:35]
    s_waitcnt lgkmcnt(7)
    ds_read_b128 v[140:143], v217 offset:18432
    v_mfma_f32_16x16x32_bf16 v[36:39], v[200:203], v[152:155], v[36:39]
    s_mov_b32 exec_hi, 0
    buffer_load_dwordx4 v23, s[4:7], s82 offen offset:2048 lds
    s_mov_b32 exec_hi, -1
    v_mfma_f32_16x16x32_bf16 v[40:43], v[204:207], v[152:155], v[40:43]
    s_waitcnt lgkmcnt(7)
    ds_read_b128 v[144:147], v217 offset:20480
    v_mfma_f32_16x16x32_bf16 v[44:47], v[200:203], v[156:159], v[44:47]
    ds_read_b128 v[148:151], v217 offset:22528
    v_mfma_f32_16x16x32_bf16 v[48:51], v[204:207], v[156:159], v[48:51]
    s_waitcnt lgkmcnt(8)
    v_mfma_f32_16x16x32_bf16 v[52:55], v[200:203], v[160:163], v[52:55]
    ds_read_b128 v[152:155], v217 offset:24576
    v_mfma_f32_16x16x32_bf16 v[56:59], v[204:207], v[160:163], v[56:59]
    s_waitcnt lgkmcnt(8)
    v_mfma_f32_16x16x32_bf16 v[60:63], v[200:203], v[164:167], v[60:63]
    v_mfma_f32_16x16x32_bf16 v[64:67], v[204:207], v[164:167], v[64:67]
    s_waitcnt lgkmcnt(7)
    v_mfma_f32_16x16x32_bf16 v[68:71], v[200:203], v[168:171], v[68:71]
    v_mfma_f32_16x16x32_bf16 v[72:75], v[204:207], v[168:171], v[72:75]
    s_waitcnt lgkmcnt(6)
    v_mfma_f32_16x16x32_bf16 v[76:79], v[200:203], v[172:175], v[76:79]
    s_waitcnt vmcnt(11) lgkmcnt(0)
    s_barrier
    v_mfma_f32_16x16x32_bf16 v[80:83], v[204:207], v[172:175], v[80:83]
    ds_read_b64_tr_b16 v[208:209], v223 offset:0
    s_add_u32 m0, s86, 0
    s_mul_i32 s84, s83, 1536
    v_mfma_f32_16x16x32_bf16 v[84:87], v[200:203], v[132:135], v[84:87]
    buffer_load_dwordx4 v24, s[8:11], s84 offen offset:0 lds
    v_mfma_f32_16x16x32_bf16 v[88:91], v[204:207], v[132:135], v[88:91]
    ds_read_b64_tr_b16 v[210:211], v223 offset:512
    v_mfma_f32_16x16x32_bf16 v[92:95], v[200:203], v[136:139], v[92:95]
    ds_read_b64_tr_b16 v[212:213], v223 offset:2048
    v_mfma_f32_16x16x32_bf16 v[96:99], v[204:207], v[136:139], v[96:99]
    buffer_load_dwordx4 v25, s[8:11], s84 offen offset:1024 lds
    v_mfma_f32_16x16x32_bf16 v[100:103], v[200:203], v[140:143], v[100:103]
    ds_read_b64_tr_b16 v[214:215], v223 offset:2560
    v_mfma_f32_16x16x32_bf16 v[104:107], v[204:207], v[140:143], v[104:107]
    ds_read_b128 v[156:159], v218 offset:0
    v_mfma_f32_16x16x32_bf16 v[108:111], v[200:203], v[144:147], v[108:111]
    ds_read_b128 v[160:163], v218 offset:2048
    v_mfma_f32_16x16x32_bf16 v[112:115], v[204:207], v[144:147], v[112:115]
    buffer_load_dwordx4 v24, s[12:15], s84 offen offset:2048 lds
    v_mfma_f32_16x16x32_bf16 v[116:119], v[200:203], v[148:151], v[116:119]
    ds_read_b128 v[164:167], v218 offset:4096
    v_mfma_f32_16x16x32_bf16 v[120:123], v[204:207], v[148:151], v[120:123]
    ds_read_b128 v[168:171], v218 offset:6144
    v_mfma_f32_16x16x32_bf16 v[124:127], v[200:203], v[152:155], v[124:127]
    ds_read_b128 v[172:175], v218 offset:8192
    v_mfma_f32_16x16x32_bf16 v[128:131], v[204:207], v[152:155], v[128:131]
    s_waitcnt lgkmcnt(4)
    buffer_load_dwordx4 v25, s[12:15], s84 offen offset:3072 lds
    s_mov_b64 s[72:73], 0
    s_mov_b64 s[74:75], 0
    s_buffer_load_dwordx4 s[72:75], s[36:39], s71 offset:0
    v_mfma_f32_16x16x32_bf16 v[28:31], v[208:211], v[156:159], v[28:31]
    ds_read_b128 v[132:135], v218 offset:10240
    s_add_u32 m0, s85, 0
    v_mfma_f32_16x16x32_bf16 v[32:35], v[212:215], v[156:159], v[32:35]
    s_waitcnt lgkmcnt(4)
    ds_read_b128 v[136:139], v218 offset:12288
    v_mfma_f32_16x16x32_bf16 v[36:39], v[208:211], v[160:163], v[36:39]
    ds_read_b128 v[140:143], v218 offset:14336
    v_mfma_f32_16x16x32_bf16 v[40:43], v[212:215], v[160:163], v[40:43]
    s_waitcnt lgkmcnt(5)
    buffer_load_dwordx4 v17, s[4:7], s83 offen offset:0 lds
    v_mfma_f32_16x16x32_bf16 v[44:47], v[208:211], v[164:167], v[44:47]
    ds_read_b128 v[144:147], v218 offset:16384
    v_mfma_f32_16x16x32_bf16 v[48:51], v[212:215], v[164:167], v[48:51]
    s_waitcnt lgkmcnt(5)
    ds_read_b128 v[148:151], v218 offset:18432
    v_mfma_f32_16x16x32_bf16 v[52:55], v[208:211], v[168:171], v[52:55]
    ds_read_b128 v[152:155], v218 offset:20480
    v_mfma_f32_16x16x32_bf16 v[56:59], v[212:215], v[168:171], v[56:59]
    s_waitcnt lgkmcnt(6)
    buffer_load_dwordx4 v18, s[4:7], s83 offen offset:1024 lds
    v_mfma_f32_16x16x32_bf16 v[60:63], v[208:211], v[172:175], v[60:63]
    ds_read_b128 v[156:159], v218 offset:22528
    v_mfma_f32_16x16x32_bf16 v[64:67], v[212:215], v[172:175], v[64:67]
    s_waitcnt lgkmcnt(6)
    ds_read_b128 v[160:163], v218 offset:24576
    v_mfma_f32_16x16x32_bf16 v[68:71], v[208:211], v[132:135], v[68:71]
    ds_read_b64_tr_b16 v[176:177], v223 offset:8192
    v_mfma_f32_16x16x32_bf16 v[72:75], v[212:215], v[132:135], v[72:75]
    s_waitcnt lgkmcnt(7)
    buffer_load_dwordx4 v19, s[4:7], s83 offen offset:2048 lds
    v_mfma_f32_16x16x32_bf16 v[76:79], v[208:211], v[136:139], v[76:79]
    ds_read_b64_tr_b16 v[178:179], v223 offset:8704
    v_mfma_f32_16x16x32_bf16 v[80:83], v[212:215], v[136:139], v[80:83]
    s_waitcnt lgkmcnt(7)
    ds_read_b64_tr_b16 v[180:181], v223 offset:10240
    v_mfma_f32_16x16x32_bf16 v[84:87], v[208:211], v[140:143], v[84:87]
    ds_read_b64_tr_b16 v[182:183], v223 offset:10752
    v_mfma_f32_16x16x32_bf16 v[88:91], v[212:215], v[140:143], v[88:91]
    s_waitcnt lgkmcnt(8)
    buffer_load_dwordx4 v20, s[4:7], s83 offen offset:3072 lds
    v_mfma_f32_16x16x32_bf16 v[92:95], v[208:211], v[144:147], v[92:95]
    ds_read_b128 v[164:167], v219 offset:0
    s_add_u32 m0, s85, 4096
    v_mfma_f32_16x16x32_bf16 v[96:99], v[212:215], v[144:147], v[96:99]
    s_waitcnt lgkmcnt(8)
    ds_read_b128 v[168:171], v219 offset:2048
    v_mfma_f32_16x16x32_bf16 v[100:103], v[208:211], v[148:151], v[100:103]
    ds_read_b128 v[172:175], v219 offset:4096
    v_mfma_f32_16x16x32_bf16 v[104:107], v[212:215], v[148:151], v[104:107]
    s_waitcnt lgkmcnt(9)
    buffer_load_dwordx4 v21, s[4:7], s83 offen offset:0 lds
    v_mfma_f32_16x16x32_bf16 v[108:111], v[208:211], v[152:155], v[108:111]
    ds_read_b128 v[132:135], v219 offset:6144
    v_mfma_f32_16x16x32_bf16 v[112:115], v[212:215], v[152:155], v[112:115]
    s_waitcnt lgkmcnt(9)
    ds_read_b128 v[136:139], v219 offset:8192
    v_mfma_f32_16x16x32_bf16 v[116:119], v[208:211], v[156:159], v[116:119]
    ds_read_b128 v[140:143], v219 offset:10240
    v_mfma_f32_16x16x32_bf16 v[120:123], v[212:215], v[156:159], v[120:123]
    s_waitcnt lgkmcnt(10)
    buffer_load_dwordx4 v22, s[4:7], s83 offen offset:1024 lds
    v_mfma_f32_16x16x32_bf16 v[124:127], v[208:211], v[160:163], v[124:127]
    ds_read_b128 v[144:147], v219 offset:12288
    v_mfma_f32_16x16x32_bf16 v[128:131], v[212:215], v[160:163], v[128:131]
    s_waitcnt lgkmcnt(6)
    ds_read_b128 v[148:151], v219 offset:14336
    v_mfma_f32_16x16x32_bf16 v[28:31], v[176:179], v[164:167], v[28:31]
    ds_read_b128 v[152:155], v219 offset:16384
    v_mfma_f32_16x16x32_bf16 v[32:35], v[180:183], v[164:167], v[32:35]
    s_waitcnt lgkmcnt(7)
    s_mov_b32 exec_hi, 0
    buffer_load_dwordx4 v23, s[4:7], s83 offen offset:2048 lds
    s_mov_b32 exec_hi, -1
    s_cmp_eq_u64 s[72:73], s[52:53]
    s_cbranch_scc0 L_pr1_slow
    s_cmp_eq_u64 s[74:75], s[52:53]
    s_cbranch_scc0 L_pr1_slow
L_pr1_out:
    v_mfma_f32_16x16x32_bf16 v[36:39], v[176:179], v[168:171], v[36:39]
    ds_read_b128 v[156:159], v219 offset:18432
    v_mfma_f32_16x16x32_bf16 v[40:43], v[180:183], v[168:171], v[40:43]
    s_waitcnt lgkmcnt(7)
    s_mov_b32 s56, 0
    buffer_load_dwordx4 a[0:3], v10, s[28:31], s56 offen offset:0 sc1
    v_mfma_f32_16x16x32_bf16 v[44:47], v[176:179], v[172:175], v[44:47]
    ds_read_b128 v[160:163], v219 offset:20480
    v_mfma_f32_16x16x32_bf16 v[48:51], v[180:183], v[172:175], v[48:51]
    s_waitcnt lgkmcnt(7)
    ds_read_b128 v[164:167], v219 offset:22528
    v_mfma_f32_16x16x32_bf16 v[52:55], v[176:179], v[132:135], v[52:55]
    ds_read_b128 v[168:171], v219 offset:24576
    v_mfma_f32_16x16x32_bf16 v[56:59], v[180:183], v[132:135], v[56:59]
    s_waitcnt lgkmcnt(8)
    buffer_load_dwordx4 a[4:7], v10, s[28:31], s56 offen offset:1024 sc1
    v_mfma_f32_16x16x32_bf16 v[60:63], v[176:179], v[136:139], v[60:63]
    v_mfma_f32_16x16x32_bf16 v[64:67], v[180:183], v[136:139], v[64:67]
    s_waitcnt lgkmcnt(7)
    v_mfma_f32_16x16x32_bf16 v[68:71], v[176:179], v[140:143], v[68:71]
    v_mfma_f32_16x16x32_bf16 v[72:75], v[180:183], v[140:143], v[72:75]
    s_waitcnt lgkmcnt(6)
    buffer_load_dwordx4 a[8:11], v10, s[28:31], s56 offen offset:2048 sc1
    v_mfma_f32_16x16x32_bf16 v[76:79], v[176:179], v[144:147], v[76:79]
    s_waitcnt vmcnt(14)
    s_barrier
    v_mfma_f32_16x16x32_bf16 v[80:83], v[180:183], v[144:147], v[80:83]
    s_waitcnt lgkmcnt(5)
    ds_read_b64_tr_b16 v[184:185], v224 offset:0
    v_mfma_f32_16x16x32_bf16 v[84:87], v[176:179], v[148:151], v[84:87]
    buffer_load_dwordx4 a[12:15], v10, s[28:31], s56 offen offset:3072 sc1
    v_mfma_f32_16x16x32_bf16 v[88:91], v[180:183], v[148:151], v[88:91]
    s_waitcnt lgkmcnt(5)
    ds_read_b64_tr_b16 v[186:187], v224 offset:512
    v_mfma_f32_16x16x32_bf16 v[92:95], v[176:179], v[152:155], v[92:95]
    s_waitcnt vmcnt(4)
    s_barrier
    v_mfma_f32_16x16x32_bf16 v[96:99], v[180:183], v[152:155], v[96:99]
    s_waitcnt lgkmcnt(5)
    ds_read_b64_tr_b16 v[188:189], v224 offset:2048
    v_mfma_f32_16x16x32_bf16 v[100:103], v[176:179], v[156:159], v[100:103]
    s_mov_b32 s56, 49152
    buffer_load_dwordx4 a[48:51], v10, s[28:31], s56 offen offset:0 sc1
    v_mfma_f32_16x16x32_bf16 v[104:107], v[180:183], v[156:159], v[104:107]
    s_waitcnt lgkmcnt(5)
    ds_read_b64_tr_b16 v[190:191], v224 offset:2560
    v_mfma_f32_16x16x32_bf16 v[108:111], v[176:179], v[160:163], v[108:111]
    ds_read_b128 v[172:175], v220 offset:0
    v_mfma_f32_16x16x32_bf16 v[112:115], v[180:183], v[160:163], v[112:115]
    s_waitcnt lgkmcnt(6)
    ds_read_b64_tr_b16 v[192:193], v224 offset:8192
    v_mfma_f32_16x16x32_bf16 v[116:119], v[176:179], v[164:167], v[116:119]
    ds_read_b64_tr_b16 v[194:195], v224 offset:8704
    v_mfma_f32_16x16x32_bf16 v[120:123], v[180:183], v[164:167], v[120:123]
    s_waitcnt lgkmcnt(7)
    ds_read_b64_tr_b16 v[196:197], v224 offset:10240
    v_mfma_f32_16x16x32_bf16 v[124:127], v[176:179], v[168:171], v[124:127]
    ds_read_b64_tr_b16 v[198:199], v224 offset:10752
    v_mfma_f32_16x16x32_bf16 v[128:131], v[180:183], v[168:171], v[128:131]
    s_waitcnt lgkmcnt(4)
    ds_read_b128 v[132:135], v221 offset:0
    v_mfma_f32_16x16x32_bf16 v[28:31], v[184:187], v[172:175], v[28:31]
    ds_read_b64_tr_b16 v[200:201], v222 offset:0
    v_mfma_f32_16x16x32_bf16 v[32:35], v[188:191], v[172:175], v[32:35]
    s_waitcnt lgkmcnt(1)
    ds_read_b64_tr_b16 v[202:203], v222 offset:512
    v_mfma_f32_16x16x32_bf16 v[28:31], v[192:195], v[132:135], v[28:31]
    ds_read_b64_tr_b16 v[204:205], v222 offset:2048
    v_mfma_f32_16x16x32_bf16 v[32:35], v[196:199], v[132:135], v[32:35]
    ds_read_b64_tr_b16 v[206:207], v222 offset:2560
    ds_read_b128 v[136:139], v216 offset:0
    s_waitcnt lgkmcnt(0)
    ds_read_b64_tr_b16 v[208:209], v222 offset:8192
    v_mfma_f32_16x16x32_bf16 v[28:31], v[200:203], v[136:139], v[28:31]
    ds_read_b64_tr_b16 v[210:211], v222 offset:8704
    v_mfma_f32_16x16x32_bf16 v[32:35], v[204:207], v[136:139], v[32:35]
    ds_read_b64_tr_b16 v[212:213], v222 offset:10240
    ds_read_b64_tr_b16 v[214:215], v222 offset:10752
    ds_read_b128 v[140:143], v217 offset:0
    s_waitcnt lgkmcnt(0)
    ds_read_b128 v[144:147], v220 offset:2048
    v_mfma_f32_16x16x32_bf16 v[28:31], v[208:211], v[140:143], v[28:31]
    ds_read_b128 v[148:151], v221 offset:2048
    v_mfma_f32_16x16x32_bf16 v[32:35], v[212:215], v[140:143], v[32:35]
    s_waitcnt lgkmcnt(1)
    ds_read_b128 v[152:155], v216 offset:2048
    v_mfma_f32_16x16x32_bf16 v[36:39], v[184:187], v[144:147], v[36:39]
    ds_read_b128 v[156:159], v217 offset:2048
    v_mfma_f32_16x16x32_bf16 v[40:43], v[188:191], v[144:147], v[40:43]
    s_waitcnt lgkmcnt(2)
    buffer_load_dwordx4 a[52:55], v10, s[28:31], s56 offen offset:1024 sc1
    v_mfma_f32_16x16x32_bf16 v[36:39], v[192:195], v[148:151], v[36:39]
    ds_read_b128 v[160:163], v220 offset:4096
    v_mfma_f32_16x16x32_bf16 v[40:43], v[196:199], v[148:151], v[40:43]
    s_waitcnt lgkmcnt(2)
    ds_read_b128 v[164:167], v221 offset:4096
    v_mfma_f32_16x16x32_bf16 v[36:39], v[200:203], v[152:155], v[36:39]
    buffer_load_dwordx4 a[56:59], v10, s[28:31], s56 offen offset:2048 sc1
    v_mul_f32 v228, s89, v28
    v_mul_f32 v229, s89, v29
    v_mul_f32 v230, s89, v30
    v_mul_f32 v231, s89, v31
    v_mfma_f32_16x16x32_bf16 v[40:43], v[204:207], v[152:155], v[40:43]
    s_waitcnt lgkmcnt(2)
    ds_read_b128 v[168:171], v216 offset:4096
    v_exp_f32 v228, v228
    v_exp_f32 v229, v229
    v_mfma_f32_16x16x32_bf16 v[36:39], v[208:211], v[156:159], v[36:39]
    buffer_load_dwordx4 a[60:63], v10, s[28:31], s56 offen offset:3072 sc1
    v_exp_f32 v230, v230
    v_exp_f32 v231, v231
    v_mfma_f32_16x16x32_bf16 v[40:43], v[212:215], v[156:159], v[40:43]
    s_waitcnt lgkmcnt(2)
    ds_read_b128 v[172:175], v217 offset:4096
    v_add_f32 v228, 1.0, v228
    v_add_f32 v229, 1.0, v229
    v_add_f32 v230, 1.0, v230
    v_add_f32 v231, 1.0, v231
    v_mfma_f32_16x16x32_bf16 v[44:47], v[184:187], v[160:163], v[44:47]
    s_mov_b32 s56, 98304
    buffer_load_dwordx4 a[96:99], v10, s[28:31], s56 offen offset:0 sc1
    v_rcp_f32 v228, v228
    v_rcp_f32 v229, v229
    v_mfma_f32_16x16x32_bf16 v[48:51], v[188:191], v[160:163], v[48:51]
    s_waitcnt lgkmcnt(2)
    ds_read_b128 v[132:135], v220 offset:6144
    v_rcp_f32 v230, v230
    v_rcp_f32 v231, v231
    v_mfma_f32_16x16x32_bf16 v[44:47], v[192:195], v[164:167], v[44:47]
    buffer_load_dwordx4 a[100:103], v10, s[28:31], s56 offen offset:1024 sc1
    v_mul_f32 v28, v28, v228
    v_mul_f32 v29, v29, v229
    v_mul_f32 v30, v30, v230
    v_mul_f32 v31, v31, v231
    v_mfma_f32_16x16x32_bf16 v[48:51], v[196:199], v[164:167], v[48:51]
    s_waitcnt lgkmcnt(2)
    ds_read_b128 v[136:139], v221 offset:6144
    v_mul_f32 v28, v28, v32
    v_mul_f32 v29, v29, v33
    v_mul_f32 v30, v30, v34
    v_mul_f32 v31, v31, v35
    v_mfma_f32_16x16x32_bf16 v[44:47], v[200:203], v[168:171], v[44:47]
    buffer_load_dwordx4 a[104:107], v10, s[28:31], s56 offen offset:2048 sc1
    v_cvt_pk_bf16_f32 v236, v28, v29
    v_cvt_pk_bf16_f32 v237, v30, v31
    v_mul_f32 v232, s89, v36
    v_mul_f32 v233, s89, v37
    v_mfma_f32_16x16x32_bf16 v[48:51], v[204:207], v[168:171], v[48:51]
    s_waitcnt lgkmcnt(2)
    ds_read_b128 v[140:143], v216 offset:6144
    v_mul_f32 v234, s89, v38
    v_mul_f32 v235, s89, v39
    v_exp_f32 v232, v232
    v_mfma_f32_16x16x32_bf16 v[44:47], v[208:211], v[172:175], v[44:47]
    buffer_load_dwordx4 a[108:111], v10, s[28:31], s56 offen offset:3072 sc1
    s_mov_b64 s[72:73], 0
    s_mov_b64 s[74:75], 0
    s_buffer_load_dwordx4 s[72:75], s[36:39], s71 offset:2048
    v_exp_f32 v233, v233
    v_exp_f32 v234, v234
    v_mfma_f32_16x16x32_bf16 v[48:51], v[212:215], v[172:175], v[48:51]
    s_waitcnt lgkmcnt(2)
    ds_read_b128 v[144:147], v217 offset:6144
    v_exp_f32 v235, v235
    v_add_f32 v232, 1.0, v232
    v_add_f32 v233, 1.0, v233
    v_mfma_f32_16x16x32_bf16 v[52:55], v[184:187], v[132:135], v[52:55]
    s_mov_b32 s56, 147456
    buffer_load_dwordx4 a[144:147], v10, s[28:31], s56 offen offset:0 sc1
    v_add_f32 v234, 1.0, v234
    v_add_f32 v235, 1.0, v235
    v_rcp_f32 v232, v232
    v_mfma_f32_16x16x32_bf16 v[56:59], v[188:191], v[132:135], v[56:59]
    s_waitcnt lgkmcnt(2)
    ds_read_b128 v[148:151], v220 offset:8192
    v_rcp_f32 v233, v233
    v_rcp_f32 v234, v234
    v_mfma_f32_16x16x32_bf16 v[52:55], v[192:195], v[136:139], v[52:55]
    buffer_load_dwordx4 a[148:151], v10, s[28:31], s56 offen offset:1024 sc1
    v_rcp_f32 v235, v235
    v_mul_f32 v36, v36, v232
    v_mul_f32 v37, v37, v233
    v_mfma_f32_16x16x32_bf16 v[56:59], v[196:199], v[136:139], v[56:59]
    s_waitcnt lgkmcnt(2)
    ds_read_b128 v[152:155], v221 offset:8192
    v_mul_f32 v38, v38, v234
    v_mul_f32 v39, v39, v235
    v_mul_f32 v36, v36, v40
    v_mul_f32 v37, v37, v41
    v_mfma_f32_16x16x32_bf16 v[52:55], v[200:203], v[140:143], v[52:55]
    buffer_load_dwordx4 a[152:155], v10, s[28:31], s56 offen offset:2048 sc1
    v_mul_f32 v38, v38, v42
    v_mul_f32 v39, v39, v43
    v_cvt_pk_bf16_f32 v238, v36, v37
    v_cvt_pk_bf16_f32 v239, v38, v39
    v_mfma_f32_16x16x32_bf16 v[56:59], v[204:207], v[140:143], v[56:59]
    s_waitcnt lgkmcnt(2)
    ds_read_b128 v[156:159], v216 offset:8192
    s_mov_b32 s90, 0
    s_nop 0
    v_permlane16_swap_b32 v236, v238
    v_permlane16_swap_b32 v237, v239
    buffer_store_dwordx4 v[236:239], v225, s[24:27], s90 offen sc1
    v_mul_f32 v228, s89, v44
    v_mul_f32 v229, s89, v45
    v_mfma_f32_16x16x32_bf16 v[52:55], v[208:211], v[144:147], v[52:55]
    buffer_load_dwordx4 a[156:159], v10, s[28:31], s56 offen offset:3072 sc1
    v_mul_f32 v230, s89, v46
    v_mul_f32 v231, s89, v47
    v_exp_f32 v228, v228
    v_mfma_f32_16x16x32_bf16 v[56:59], v[212:215], v[144:147], v[56:59]
    s_waitcnt lgkmcnt(2)
    ds_read_b128 v[160:163], v217 offset:8192
    v_exp_f32 v229, v229
    v_exp_f32 v230, v230
    v_mfma_f32_16x16x32_bf16 v[60:63], v[184:187], v[148:151], v[60:63]
    ds_read_b128 v[164:167], v220 offset:10240
    v_exp_f32 v231, v231
    v_add_f32 v228, 1.0, v228
    v_add_f32 v229, 1.0, v229
    v_mfma_f32_16x16x32_bf16 v[64:67], v[188:191], v[148:151], v[64:67]
    s_waitcnt lgkmcnt(3)
    s_add_u32 s56, s70, 0
    buffer_load_dwordx4 a[192:195], v10, s[28:31], s56 offen offset:0 sc1
    v_add_f32 v230, 1.0, v230
    v_add_f32 v231, 1.0, v231
    v_rcp_f32 v228, v228
    v_mfma_f32_16x16x32_bf16 v[60:63], v[192:195], v[152:155], v[60:63]
    ds_read_b128 v[168:171], v221 offset:10240
    v_rcp_f32 v229, v229
    v_rcp_f32 v230, v230
    v_mfma_f32_16x16x32_bf16 v[64:67], v[196:199], v[152:155], v[64:67]
    s_waitcnt lgkmcnt(3)
    ds_read_b128 v[172:175], v216 offset:10240
    v_rcp_f32 v231, v231
    v_mul_f32 v44, v44, v228
    v_mul_f32 v45, v45, v229
    v_mfma_f32_16x16x32_bf16 v[60:63], v[200:203], v[156:159], v[60:63]
    buffer_load_dwordx4 a[196:199], v10, s[28:31], s56 offen offset:1024 sc1
    v_mul_f32 v46, v46, v230
    v_mul_f32 v47, v47, v231
    v_mul_f32 v44, v44, v48
    v_mul_f32 v45, v45, v49
    v_mfma_f32_16x16x32_bf16 v[64:67], v[204:207], v[156:159], v[64:67]
    s_waitcnt lgkmcnt(3)
    ds_read_b128 v[132:135], v217 offset:10240
    v_mul_f32 v46, v46, v50
    v_mul_f32 v47, v47, v51
    v_cvt_pk_bf16_f32 v240, v44, v45
    v_cvt_pk_bf16_f32 v241, v46, v47
    v_mfma_f32_16x16x32_bf16 v[60:63], v[208:211], v[160:163], v[60:63]
    ds_read_b128 v[136:139], v220 offset:12288
    v_mul_f32 v232, s89, v52
    v_mul_f32 v233, s89, v53
    v_mul_f32 v234, s89, v54
    v_mul_f32 v235, s89, v55
    v_mfma_f32_16x16x32_bf16 v[64:67], v[212:215], v[160:163], v[64:67]
    s_waitcnt lgkmcnt(4)
    buffer_load_dwordx4 a[200:203], v10, s[28:31], s56 offen offset:2048 sc1
    v_exp_f32 v232, v232
    v_exp_f32 v233, v233
    v_mfma_f32_16x16x32_bf16 v[68:71], v[184:187], v[164:167], v[68:71]
    ds_read_b128 v[140:143], v221 offset:12288
    v_exp_f32 v234, v234
    v_exp_f32 v235, v235
    v_mfma_f32_16x16x32_bf16 v[72:75], v[188:191], v[164:167], v[72:75]
    s_waitcnt lgkmcnt(4)
    ds_read_b128 v[144:147], v216 offset:12288
    v_add_f32 v232, 1.0, v232
    v_add_f32 v233, 1.0, v233
    v_add_f32 v234, 1.0, v234
    v_add_f32 v235, 1.0, v235
    v_mfma_f32_16x16x32_bf16 v[68:71], v[192:195], v[168:171], v[68:71]
    ds_read_b128 v[148:151], v217 offset:12288
    v_rcp_f32 v232, v232
    v_rcp_f32 v233, v233
    v_mfma_f32_16x16x32_bf16 v[72:75], v[196:199], v[168:171], v[72:75]
    s_waitcnt lgkmcnt(5)
    buffer_load_dwordx4 a[204:207], v10, s[28:31], s56 offen offset:3072 sc1
    s_cmp_eq_u64 s[72:73], s[52:53]
    s_cbranch_scc0 L_pr2_slow
    s_cmp_eq_u64 s[74:75], s[52:53]
    s_cbranch_scc0 L_pr2_slow
L_pr2_out:
    v_rcp_f32 v234, v234
    v_rcp_f32 v235, v235
    v_mfma_f32_16x16x32_bf16 v[68:71], v[200:203], v[172:175], v[68:71]
    ds_read_b128 v[152:155], v220 offset:14336
    v_mul_f32 v52, v52, v232
    v_mul_f32 v53, v53, v233
    v_mul_f32 v54, v54, v234
    v_mul_f32 v55, v55, v235
    v_mfma_f32_16x16x32_bf16 v[72:75], v[204:207], v[172:175], v[72:75]
    s_waitcnt lgkmcnt(5)
    s_mov_b32 s56, 4096
    buffer_load_dwordx4 a[16:19], v10, s[28:31], s56 offen offset:0 sc1
    v_mul_f32 v52, v52, v56
    v_mul_f32 v53, v53, v57
    v_mul_f32 v54, v54, v58
    v_mul_f32 v55, v55, v59
    v_mfma_f32_16x16x32_bf16 v[68:71], v[208:211], v[132:135], v[68:71]
    ds_read_b128 v[156:159], v221 offset:14336
    v_cvt_pk_bf16_f32 v242, v52, v53
    v_cvt_pk_bf16_f32 v243, v54, v55
    s_mov_b32 s90, 98304
    s_nop 0
    v_permlane16_swap_b32 v240, v242
    v_permlane16_swap_b32 v241, v243
    buffer_store_dwordx4 v[240:243], v225, s[24:27], s90 offen sc1
    v_mfma_f32_16x16x32_bf16 v[72:75], v[212:215], v[132:135], v[72:75]
    s_waitcnt lgkmcnt(5)
    ds_read_b128 v[160:163], v216 offset:14336
    v_mul_f32 v228, s89, v60
    v_mul_f32 v229, s89, v61
    v_mul_f32 v230, s89, v62
    v_mul_f32 v231, s89, v63
    v_mfma_f32_16x16x32_bf16 v[76:79], v[184:187], v[136:139], v[76:79]
    buffer_load_dwordx4 a[20:23], v10, s[28:31], s56 offen offset:1024 sc1
    v_exp_f32 v228, v228
    v_exp_f32 v229, v229
    v_mfma_f32_16x16x32_bf16 v[80:83], v[188:191], v[136:139], v[80:83]
    s_waitcnt lgkmcnt(5)
    ds_read_b128 v[164:167], v217 offset:14336
    v_exp_f32 v230, v230
    v_exp_f32 v231, v231
    v_mfma_f32_16x16x32_bf16 v[76:79], v[192:195], v[140:143], v[76:79]
    ds_read_b128 v[168:171], v220 offset:16384
    v_add_f32 v228, 1.0, v228
    v_add_f32 v229, 1.0, v229
    v_add_f32 v230, 1.0, v230
    v_add_f32 v231, 1.0, v231
    v_mfma_f32_16x16x32_bf16 v[80:83], v[196:199], v[140:143], v[80:83]
    s_waitcnt lgkmcnt(6)
    buffer_load_dwordx4 a[24:27], v10, s[28:31], s56 offen offset:2048 sc1
    v_rcp_f32 v228, v228
    v_rcp_f32 v229, v229
    v_mfma_f32_16x16x32_bf16 v[76:79], v[200:203], v[144:147], v[76:79]
    ds_read_b128 v[172:175], v221 offset:16384
    v_rcp_f32 v230, v230
    v_rcp_f32 v231, v231
    v_mfma_f32_16x16x32_bf16 v[80:83], v[204:207], v[144:147], v[80:83]
    s_waitcnt lgkmcnt(6)
    ds_read_b128 v[132:135], v216 offset:16384
    v_mul_f32 v60, v60, v228
    v_mul_f32 v61, v61, v229
    v_mul_f32 v62, v62, v230
    v_mul_f32 v63, v63, v231
    v_mfma_f32_16x16x32_bf16 v[76:79], v[208:211], v[148:151], v[76:79]
    buffer_load_dwordx4 a[28:31], v10, s[28:31], s56 offen offset:3072 sc1
    v_mul_f32 v60, v60, v64
    v_mul_f32 v61, v61, v65
    v_mul_f32 v62, v62, v66
    v_mul_f32 v63, v63, v67
    v_mfma_f32_16x16x32_bf16 v[80:83], v[212:215], v[148:151], v[80:83]
    s_waitcnt lgkmcnt(6)
    ds_read_b128 v[136:139], v217 offset:16384
    v_cvt_pk_bf16_f32 v236, v60, v61
    v_cvt_pk_bf16_f32 v237, v62, v63
    v_mul_f32 v232, s89, v68
    v_mul_f32 v233, s89, v69
    v_mfma_f32_16x16x32_bf16 v[84:87], v[184:187], v[152:155], v[84:87]
    ds_read_b128 v[140:143], v220 offset:18432
    v_mul_f32 v234, s89, v70
    v_mul_f32 v235, s89, v71
    v_exp_f32 v232, v232
    v_mfma_f32_16x16x32_bf16 v[88:91], v[188:191], v[152:155], v[88:91]
    s_waitcnt lgkmcnt(7)
    ds_read_b128 v[144:147], v221 offset:18432
    v_exp_f32 v233, v233
    v_exp_f32 v234, v234
    v_mfma_f32_16x16x32_bf16 v[84:87], v[192:195], v[156:159], v[84:87]
    s_mov_b32 s56, 53248
    buffer_load_dwordx4 a[64:67], v10, s[28:31], s56 offen offset:0 sc1
    v_exp_f32 v235, v235
    v_add_f32 v232, 1.0, v232
    v_add_f32 v233, 1.0, v233
    v_mfma_f32_16x16x32_bf16 v[88:91], v[196:199], v[156:159], v[88:91]
    s_waitcnt lgkmcnt(7)
    ds_read_b128 v[148:151], v216 offset:18432
    v_add_f32 v234, 1.0, v234
    v_add_f32 v235, 1.0, v235
    v_rcp_f32 v232, v232
    v_mfma_f32_16x16x32_bf16 v[84:87], v[200:203], v[160:163], v[84:87]
    ds_read_b128 v[152:155], v217 offset:18432
    v_rcp_f32 v233, v233
    v_rcp_f32 v234, v234
    v_mfma_f32_16x16x32_bf16 v[88:91], v[204:207], v[160:163], v[88:91]
    s_waitcnt lgkmcnt(8)
    buffer_load_dwordx4 a[68:71], v10, s[28:31], s56 offen offset:1024 sc1
    v_rcp_f32 v235, v235
    v_mul_f32 v68, v68, v232
    v_mul_f32 v69, v69, v233
    v_mfma_f32_16x16x32_bf16 v[84:87], v[208:211], v[164:167], v[84:87]
    ds_read_b128 v[156:159], v220 offset:20480
    v_mul_f32 v70, v70, v234
    v_mul_f32 v71, v71, v235
    v_mul_f32 v68, v68, v72
    v_mul_f32 v69, v69, v73
    v_mfma_f32_16x16x32_bf16 v[88:91], v[212:215], v[164:167], v[88:91]
    s_waitcnt lgkmcnt(8)
    v_mul_f32 v70, v70, v74
    v_mul_f32 v71, v71, v75
    v_cvt_pk_bf16_f32 v238, v68, v69
    v_cvt_pk_bf16_f32 v239, v70, v71
    v_mfma_f32_16x16x32_bf16 v[92:95], v[184:187], v[168:171], v[92:95]
    buffer_load_dwordx4 a[72:75], v10, s[28:31], s56 offen offset:2048 sc1
    s_mov_b32 s90, 196608
    s_nop 0
    v_permlane16_swap_b32 v236, v238
    v_permlane16_swap_b32 v237, v239
    buffer_store_dwordx4 v[236:239], v225, s[24:27], s90 offen sc1
    v_mul_f32 v228, s89, v76
    v_mul_f32 v229, s89, v77
    v_mfma_f32_16x16x32_bf16 v[96:99], v[188:191], v[168:171], v[96:99]
    s_waitcnt lgkmcnt(7)
    ds_read_b128 v[160:163], v221 offset:20480
    v_mul_f32 v230, s89, v78
    v_mul_f32 v231, s89, v79
    v_exp_f32 v228, v228
    v_mfma_f32_16x16x32_bf16 v[92:95], v[192:195], v[172:175], v[92:95]
    ds_read_b128 v[164:167], v216 offset:20480
    v_exp_f32 v229, v229
    v_exp_f32 v230, v230
    v_mfma_f32_16x16x32_bf16 v[96:99], v[196:199], v[172:175], v[96:99]
    s_waitcnt lgkmcnt(8)
    buffer_load_dwordx4 a[76:79], v10, s[28:31], s56 offen offset:3072 sc1
    v_exp_f32 v231, v231
    v_add_f32 v228, 1.0, v228
    v_add_f32 v229, 1.0, v229
    v_mfma_f32_16x16x32_bf16 v[92:95], v[200:203], v[132:135], v[92:95]
    ds_read_b128 v[168:171], v217 offset:20480
    v_add_f32 v230, 1.0, v230
    v_add_f32 v231, 1.0, v231
    v_rcp_f32 v228, v228
    v_mfma_f32_16x16x32_bf16 v[96:99], v[204:207], v[132:135], v[96:99]
    s_waitcnt lgkmcnt(8)
    v_rcp_f32 v229, v229
    v_rcp_f32 v230, v230
    v_mfma_f32_16x16x32_bf16 v[92:95], v[208:211], v[136:139], v[92:95]
    s_mov_b32 s56, 102400
    buffer_load_dwordx4 a[112:115], v10, s[28:31], s56 offen offset:0 sc1
    v_rcp_f32 v231, v231
    v_mul_f32 v76, v76, v228
    v_mul_f32 v77, v77, v229
    v_mfma_f32_16x16x32_bf16 v[96:99], v[212:215], v[136:139], v[96:99]
    s_waitcnt lgkmcnt(7)
    ds_read_b128 v[172:175], v220 offset:22528
    v_mul_f32 v78, v78, v230
    v_mul_f32 v79, v79, v231
    v_mul_f32 v76, v76, v80
    v_mul_f32 v77, v77, v81
    v_mfma_f32_16x16x32_bf16 v[100:103], v[184:187], v[140:143], v[100:103]
    ds_read_b128 v[132:135], v221 offset:22528
    v_mul_f32 v78, v78, v82
    v_mul_f32 v79, v79, v83
    v_cvt_pk_bf16_f32 v240, v76, v77
    v_cvt_pk_bf16_f32 v241, v78, v79
    v_mfma_f32_16x16x32_bf16 v[104:107], v[188:191], v[140:143], v[104:107]
    s_waitcnt lgkmcnt(8)
    buffer_load_dwordx4 a[116:119], v10, s[28:31], s56 offen offset:1024 sc1
    s_waitcnt vmcnt(10)
    s_barrier
    s_cmp_lg_u32 s44, 0
    s_cbranch_scc1 L_pub1
    s_mov_b64 exec, 1
    buffer_store_dword v8, off, s[36:39], s51 sc1
    s_mov_b64 exec, -1
L_pub1:
    s_add_u32 s51, s51, 40960
    v_mul_f32 v232, s89, v84
    v_mul_f32 v233, s89, v85
    v_mfma_f32_16x16x32_bf16 v[100:103], v[192:195], v[144:147], v[100:103]
    ds_read_b128 v[136:139], v216 offset:22528
    v_mul_f32 v234, s89, v86
    v_mul_f32 v235, s89, v87
    v_exp_f32 v232, v232
    v_mfma_f32_16x16x32_bf16 v[104:107], v[196:199], v[144:147], v[104:107]
    s_waitcnt lgkmcnt(8)
    buffer_load_dwordx4 a[120:123], v10, s[28:31], s56 offen offset:2048 sc1
    v_exp_f32 v233, v233
    v_exp_f32 v234, v234
    v_mfma_f32_16x16x32_bf16 v[100:103], v[200:203], v[148:151], v[100:103]
    ds_read_b128 v[140:143], v217 offset:22528
    v_exp_f32 v235, v235
    v_add_f32 v232, 1.0, v232
    v_add_f32 v233, 1.0, v233
    v_mfma_f32_16x16x32_bf16 v[104:107], v[204:207], v[148:151], v[104:107]
    s_waitcnt lgkmcnt(8)
    v_add_f32 v234, 1.0, v234
    v_add_f32 v235, 1.0, v235
    v_rcp_f32 v232, v232
    v_mfma_f32_16x16x32_bf16 v[100:103], v[208:211], v[152:155], v[100:103]
    ds_read_b128 v[144:147], v220 offset:24576
    v_rcp_f32 v233, v233
    v_rcp_f32 v234, v234
    v_mfma_f32_16x16x32_bf16 v[104:107], v[212:215], v[152:155], v[104:107]
    s_waitcnt lgkmcnt(8)
    buffer_load_dwordx4 a[124:127], v10, s[28:31], s56 offen offset:3072 sc1
    s_mov_b64 s[72:73], 0
    s_mov_b64 s[74:75], 0
    s_buffer_load_dwordx4 s[72:75], s[36:39], s71 offset:4096
    v_rcp_f32 v235, v235
    v_mul_f32 v84, v84, v232
    v_mul_f32 v85, v85, v233
    v_mfma_f32_16x16x32_bf16 v[108:111], v[184:187], v[156:159], v[108:111]
    ds_read_b128 v[148:151], v221 offset:24576
    v_mul_f32 v86, v86, v234
    v_mul_f32 v87, v87, v235
    v_mul_f32 v84, v84, v88
    v_mul_f32 v85, v85, v89
    v_mfma_f32_16x16x32_bf16 v[112:115], v[188:191], v[156:159], v[112:115]
    s_waitcnt lgkmcnt(8)
    s_mov_b32 s56, 151552
    buffer_load_dwordx4 a[160:163], v10, s[28:31], s56 offen offset:0 sc1
    v_mul_f32 v86, v86, v90
    v_mul_f32 v87, v87, v91
    v_cvt_pk_bf16_f32 v242, v84, v85
    v_cvt_pk_bf16_f32 v243, v86, v87
    v_mfma_f32_16x16x32_bf16 v[108:111], v[192:195], v[160:163], v[108:111]
    ds_read_b128 v[152:155], v216 offset:24576
    s_mov_b32 s90, 294912
    s_nop 0
    v_permlane16_swap_b32 v240, v242
    v_permlane16_swap_b32 v241, v243
    buffer_store_dwordx4 v[240:243], v225, s[24:27], s90 offen sc1
    v_mul_f32 v228, s89, v92
    v_mul_f32 v229, s89, v93
    v_mfma_f32_16x16x32_bf16 v[112:115], v[196:199], v[160:163], v[112:115]
    s_waitcnt lgkmcnt(8)
    v_mul_f32 v230, s89, v94
    v_mul_f32 v231, s89, v95
    v_exp_f32 v228, v228
    v_mfma_f32_16x16x32_bf16 v[108:111], v[200:203], v[164:167], v[108:111]
    buffer_load_dwordx4 a[164:167], v10, s[28:31], s56 offen offset:1024 sc1
    v_exp_f32 v229, v229
    v_exp_f32 v230, v230
    v_mfma_f32_16x16x32_bf16 v[112:115], v[204:207], v[164:167], v[112:115]
    s_waitcnt lgkmcnt(7)
    ds_read_b128 v[156:159], v217 offset:24576
    v_exp_f32 v231, v231
    v_add_f32 v228, 1.0, v228
    v_add_f32 v229, 1.0, v229
    v_mfma_f32_16x16x32_bf16 v[108:111], v[208:211], v[168:171], v[108:111]
    v_add_f32 v230, 1.0, v230
    v_add_f32 v231, 1.0, v231
    v_rcp_f32 v228, v228
    v_mfma_f32_16x16x32_bf16 v[112:115], v[212:215], v[168:171], v[112:115]
    s_waitcnt lgkmcnt(7)
    buffer_load_dwordx4 a[168:171], v10, s[28:31], s56 offen offset:2048 sc1
    v_rcp_f32 v229, v229
    v_rcp_f32 v230, v230
    v_mfma_f32_16x16x32_bf16 v[116:119], v[184:187], v[172:175], v[116:119]
    v_rcp_f32 v231, v231
    v_mul_f32 v92, v92, v228
    v_mul_f32 v93, v93, v229
    v_mfma_f32_16x16x32_bf16 v[120:123], v[188:191], v[172:175], v[120:123]
    s_waitcnt lgkmcnt(6)
    v_mul_f32 v94, v94, v230
    v_mul_f32 v95, v95, v231
    v_mul_f32 v92, v92, v96
    v_mul_f32 v93, v93, v97
    v_mfma_f32_16x16x32_bf16 v[116:119], v[192:195], v[132:135], v[116:119]
    buffer_load_dwordx4 a[172:175], v10, s[28:31], s56 offen offset:3072 sc1
    v_mul_f32 v94, v94, v98
    v_mul_f32 v95, v95, v99
    v_cvt_pk_bf16_f32 v236, v92, v93
    v_cvt_pk_bf16_f32 v237, v94, v95
    v_mfma_f32_16x16x32_bf16 v[120:123], v[196:199], v[132:135], v[120:123]
    s_waitcnt lgkmcnt(5)
    v_mul_f32 v232, s89, v100
    v_mul_f32 v233, s89, v101
    v_mul_f32 v234, s89, v102
    v_mul_f32 v235, s89, v103
    v_mfma_f32_16x16x32_bf16 v[116:119], v[200:203], v[136:139], v[116:119]
    v_exp_f32 v232, v232
    v_exp_f32 v233, v233
    v_mfma_f32_16x16x32_bf16 v[120:123], v[204:207], v[136:139], v[120:123]
    s_waitcnt lgkmcnt(4)
    v_exp_f32 v234, v234
    v_exp_f32 v235, v235
    v_mfma_f32_16x16x32_bf16 v[116:119], v[208:211], v[140:143], v[116:119]
    s_add_u32 s56, s70, 4096
    buffer_load_dwordx4 a[208:211], v10, s[28:31], s56 offen offset:0 sc1
    v_add_f32 v232, 1.0, v232
    v_add_f32 v233, 1.0, v233
    v_add_f32 v234, 1.0, v234
    v_add_f32 v235, 1.0, v235
    v_mfma_f32_16x16x32_bf16 v[120:123], v[212:215], v[140:143], v[120:123]
    s_waitcnt lgkmcnt(3)
    v_rcp_f32 v232, v232
    v_rcp_f32 v233, v233
    v_mfma_f32_16x16x32_bf16 v[124:127], v[184:187], v[144:147], v[124:127]
    v_rcp_f32 v234, v234
    v_rcp_f32 v235, v235
    v_mfma_f32_16x16x32_bf16 v[128:131], v[188:191], v[144:147], v[128:131]
    s_waitcnt lgkmcnt(2)
    buffer_load_dwordx4 a[212:215], v10, s[28:31], s56 offen offset:1024 sc1
    v_mul_f32 v100, v100, v232
    v_mul_f32 v101, v101, v233
    v_mul_f32 v102, v102, v234
    v_mul_f32 v103, v103, v235
    v_mfma_f32_16x16x32_bf16 v[124:127], v[192:195], v[148:151], v[124:127]
    v_mul_f32 v100, v100, v104
    v_mul_f32 v101, v101, v105
    v_mul_f32 v102, v102, v106
    v_mul_f32 v103, v103, v107
    v_mfma_f32_16x16x32_bf16 v[128:131], v[196:199], v[148:151], v[128:131]
    s_waitcnt lgkmcnt(1)
    v_cvt_pk_bf16_f32 v238, v100, v101
    v_cvt_pk_bf16_f32 v239, v102, v103
    s_mov_b32 s90, 393216
    s_nop 0
    v_permlane16_swap_b32 v236, v238
    v_permlane16_swap_b32 v237, v239
    buffer_store_dwordx4 v[236:239], v225, s[24:27], s90 offen sc1
    v_mfma_f32_16x16x32_bf16 v[124:127], v[200:203], v[152:155], v[124:127]
    buffer_load_dwordx4 a[216:219], v10, s[28:31], s56 offen offset:2048 sc1
    v_mul_f32 v228, s89, v108
    v_mul_f32 v229, s89, v109
    v_mul_f32 v230, s89, v110
    v_mul_f32 v231, s89, v111
    v_mfma_f32_16x16x32_bf16 v[128:131], v[204:207], v[152:155], v[128:131]
    s_waitcnt lgkmcnt(0)
    v_exp_f32 v228, v228
    v_exp_f32 v229, v229
    v_mfma_f32_16x16x32_bf16 v[124:127], v[208:211], v[156:159], v[124:127]
    v_exp_f32 v230, v230
    v_exp_f32 v231, v231
    v_mfma_f32_16x16x32_bf16 v[128:131], v[212:215], v[156:159], v[128:131]
    buffer_load_dwordx4 a[220:223], v10, s[28:31], s56 offen offset:3072 sc1
    s_cmp_eq_u64 s[72:73], s[52:53]
    s_cbranch_scc0 L_pr3_slow
    s_cmp_eq_u64 s[74:75], s[52:53]
    s_cbranch_scc0 L_pr3_slow
L_pr3_out:
    v_add_f32 v228, 1.0, v228
    v_add_f32 v229, 1.0, v229
    v_add_f32 v230, 1.0, v230
    v_add_f32 v231, 1.0, v231
    s_nop 3
    v_rcp_f32 v228, v228
    v_rcp_f32 v229, v229
    v_rcp_f32 v230, v230
    v_rcp_f32 v231, v231
    v_mul_f32 v108, v108, v228
    v_mul_f32 v109, v109, v229
    v_mul_f32 v110, v110, v230
    v_mul_f32 v111, v111, v231
    s_mov_b32 s56, 8192
    buffer_load_dwordx4 a[32:35], v10, s[28:31], s56 offen offset:0 sc1
    v_mul_f32 v108, v108, v112
    v_mul_f32 v109, v109, v113
    v_mul_f32 v110, v110, v114
    v_mul_f32 v111, v111, v115
    v_cvt_pk_bf16_f32 v240, v108, v109
    v_cvt_pk_bf16_f32 v241, v110, v111
    s_waitcnt vmcnt(9)
    s_barrier
    s_cmp_lg_u32 s44, 0
    s_cbranch_scc1 L_pub2
    s_mov_b64 exec, 1
    buffer_store_dword v8, off, s[36:39], s51 sc1
    s_mov_b64 exec, -1
L_pub2:
    s_add_u32 s51, s51, 40960
    v_mul_f32 v232, s89, v116
    v_mul_f32 v233, s89, v117
    v_mul_f32 v234, s89, v118
    v_mul_f32 v235, s89, v119
    v_exp_f32 v232, v232
    v_exp_f32 v233, v233
    v_exp_f32 v234, v234
    v_exp_f32 v235, v235
    v_add_f32 v232, 1.0, v232
    v_add_f32 v233, 1.0, v233
    v_add_f32 v234, 1.0, v234
    v_add_f32 v235, 1.0, v235
    v_rcp_f32 v232, v232
    buffer_load_dwordx4 a[36:39], v10, s[28:31], s56 offen offset:1024 sc1
    v_rcp_f32 v233, v233
    v_rcp_f32 v234, v234
    v_rcp_f32 v235, v235
    v_mul_f32 v116, v116, v232
    v_mul_f32 v117, v117, v233
    v_mul_f32 v118, v118, v234
    v_mul_f32 v119, v119, v235
    v_mul_f32 v116, v116, v120
    v_mul_f32 v117, v117, v121
    v_mul_f32 v118, v118, v122
    v_mul_f32 v119, v119, v123
    v_cvt_pk_bf16_f32 v242, v116, v117
    v_cvt_pk_bf16_f32 v243, v118, v119
    s_mov_b32 s90, 491520
    s_nop 0
    v_permlane16_swap_b32 v240, v242
    v_permlane16_swap_b32 v241, v243
    buffer_store_dwordx4 v[240:243], v225, s[24:27], s90 offen sc1
    v_mul_f32 v228, s89, v124
    v_mul_f32 v229, s89, v125
    v_mul_f32 v230, s89, v126
    v_mul_f32 v231, s89, v127
    v_exp_f32 v228, v228
    v_exp_f32 v229, v229
    v_exp_f32 v230, v230
    v_exp_f32 v231, v231
    v_add_f32 v228, 1.0, v228
    v_add_f32 v229, 1.0, v229
    v_add_f32 v230, 1.0, v230
    v_add_f32 v231, 1.0, v231
    v_rcp_f32 v228, v228
    v_rcp_f32 v229, v229
    buffer_load_dwordx4 a[40:43], v10, s[28:31], s56 offen offset:2048 sc1
    v_rcp_f32 v230, v230
    v_rcp_f32 v231, v231
    v_mul_f32 v124, v124, v228
    v_mul_f32 v125, v125, v229
    v_mul_f32 v126, v126, v230
    v_mul_f32 v127, v127, v231
    v_mul_f32 v124, v124, v128
    v_mul_f32 v125, v125, v129
    v_mul_f32 v126, v126, v130
    v_mul_f32 v127, v127, v131
    v_cvt_pk_bf16_f32 v236, v124, v125
    v_cvt_pk_bf16_f32 v237, v126, v127
    s_mov_b32 s90, 589824
    s_nop 0
    v_permlane16_swap_b32 v236, v238
    v_permlane16_swap_b32 v237, v239
    s_mov_b32 exec_lo, 0xffff
    s_mov_b32 exec_hi, 0xffff
    buffer_store_dwordx4 v[236:239], v225, s[24:27], s90 offen sc1
    s_mov_b64 exec, -1
    s_waitcnt vmcnt(7)
    s_barrier
    s_cmp_lg_u32 s44, 0
    s_cbranch_scc1 L_pub3
    s_mov_b64 exec, 1
    buffer_store_dword v8, off, s[36:39], s51 sc1
    s_mov_b64 exec, -1
L_pub3:
    s_add_u32 s51, s51, 40960
    buffer_load_dwordx4 a[44:47], v10, s[28:31], s56 offen offset:3072 sc1
    s_mov_b64 s[72:73], 0
    s_mov_b64 s[74:75], 0
    s_mov_b64 s[76:77], 0
    s_buffer_load_dwordx8 s[72:79], s[36:39], s61 offset:0
    s_mov_b32 s56, 57344
    buffer_load_dwordx4 a[80:83], v10, s[28:31], s56 offen offset:0 sc1
    buffer_load_dwordx4 a[84:87], v10, s[28:31], s56 offen offset:1024 sc1
    buffer_load_dwordx4 a[88:91], v10, s[28:31], s56 offen offset:2048 sc1
    buffer_load_dwordx4 a[92:95], v10, s[28:31], s56 offen offset:3072 sc1
    s_mov_b32 s56, 106496
    buffer_load_dwordx4 a[128:131], v10, s[28:31], s56 offen offset:0 sc1
    buffer_load_dwordx4 a[132:135], v10, s[28:31], s56 offen offset:1024 sc1
    buffer_load_dwordx4 a[136:139], v10, s[28:31], s56 offen offset:2048 sc1
    buffer_load_dwordx4 a[140:143], v10, s[28:31], s56 offen offset:3072 sc1
    s_mov_b32 s56, 155648
    buffer_load_dwordx4 a[176:179], v10, s[28:31], s56 offen offset:0 sc1
    buffer_load_dwordx4 a[180:183], v10, s[28:31], s56 offen offset:1024 sc1
    s_waitcnt lgkmcnt(0)
    s_cmp_eq_u64 s[72:73], s[52:53]
    s_cbranch_scc0 L_ph0_slow
    s_cmp_eq_u64 s[74:75], s[52:53]
    s_cbranch_scc0 L_ph0_slow
    s_cmp_eq_u64 s[76:77], s[52:53]
    s_cbranch_scc0 L_ph0_slow
L_ph0_out:
    s_add_u32 s69, s57, 0
    buffer_load_dwordx4 v[28:31], v11, s[24:27], s69 offen offset:0 sc1
    buffer_load_dwordx4 a[184:187], v10, s[28:31], s56 offen offset:2048 sc1
    buffer_load_dwordx4 a[188:191], v10, s[28:31], s56 offen offset:3072 sc1
    buffer_load_dwordx4 v[32:35], v11, s[24:27], s69 offen offset:1024 sc1
    s_add_u32 s56, s70, 8192
    buffer_load_dwordx4 a[224:227], v10, s[28:31], s56 offen offset:0 sc1
    buffer_load_dwordx4 a[228:231], v10, s[28:31], s56 offen offset:1024 sc1
    buffer_load_dwordx4 v[36:39], v11, s[24:27], s69 offen offset:2048 sc1
    buffer_load_dwordx4 a[232:235], v10, s[28:31], s56 offen offset:2048 sc1
    buffer_load_dwordx4 a[236:239], v10, s[28:31], s56 offen offset:3072 sc1
    buffer_load_dwordx4 v[40:43], v11, s[24:27], s69 offen offset:3072 sc1
    s_add_u32 s69, s57, 4096
    buffer_load_dwordx4 v[44:47], v11, s[24:27], s69 offen offset:0 sc1
    s_mov_b64 s[72:73], 0
    s_mov_b64 s[74:75], 0
    s_mov_b64 s[76:77], 0
    s_buffer_load_dwordx8 s[72:79], s[36:39], s62 offset:40960
    buffer_load_dwordx4 v[48:51], v11, s[24:27], s69 offen offset:1024 sc1
    buffer_load_dwordx4 v[52:55], v11, s[24:27], s69 offen offset:2048 sc1
    buffer_load_dwordx4 v[56:59], v11, s[24:27], s69 offen offset:3072 sc1
    s_add_u32 s69, s57, 8192
    buffer_load_dwordx4 v[60:63], v11, s[24:27], s69 offen offset:0 sc1
L_join:
    v_add_u32 v168, 129024, v14
    v_add_u32 v169, 129024, v15
    s_waitcnt vmcnt(14)
    v_mfma_f32_16x16x32_bf16 v[176:179], a[0:3], v[28:31], 0
    s_waitcnt vmcnt(11)
    v_mfma_f32_16x16x32_bf16 v[176:179], a[4:7], v[32:35], v[176:179]
    buffer_load_dwordx4 v[64:67], v11, s[24:27], s69 offen offset:1024 sc1
    v_mfma_f32_16x16x32_bf16 v[180:183], a[48:51], v[28:31], 0
    v_mfma_f32_16x16x32_bf16 v[180:183], a[52:55], v[32:35], v[180:183]
    v_mfma_f32_16x16x32_bf16 v[184:187], a[96:99], v[28:31], 0
    v_mfma_f32_16x16x32_bf16 v[184:187], a[100:103], v[32:35], v[184:187]
    v_mfma_f32_16x16x32_bf16 v[188:191], a[144:147], v[28:31], 0
    buffer_load_dwordx4 v[68:71], v11, s[24:27], s69 offen offset:2048 sc1
    v_mfma_f32_16x16x32_bf16 v[188:191], a[148:151], v[32:35], v[188:191]
    v_mfma_f32_16x16x32_bf16 v[192:195], a[192:195], v[28:31], 0
    v_mfma_f32_16x16x32_bf16 v[192:195], a[196:199], v[32:35], v[192:195]
    s_barrier
    s_cmp_lg_u32 s44, 0
    s_cbranch_scc1 L_pub4
    s_mov_b64 exec, 1
    buffer_store_dword v8, off, s[36:39], s51 sc1
    s_mov_b64 exec, -1
L_pub4:
    s_waitcnt vmcnt(10)
    v_mfma_f32_16x16x32_bf16 v[176:179], a[8:11], v[36:39], v[176:179]
    s_waitcnt vmcnt(7)
    v_mfma_f32_16x16x32_bf16 v[176:179], a[12:15], v[40:43], v[176:179]
    buffer_load_dwordx4 v[72:75], v11, s[24:27], s69 offen offset:3072 sc1
    v_mfma_f32_16x16x32_bf16 v[180:183], a[56:59], v[36:39], v[180:183]
    s_cmp_eq_u64 s[72:73], s[52:53]
    s_cbranch_scc0 L_ph1_slow
    s_cmp_eq_u64 s[74:75], s[52:53]
    s_cbranch_scc0 L_ph1_slow
    s_cmp_eq_u64 s[76:77], s[52:53]
    s_cbranch_scc0 L_ph1_slow
L_ph1_out:
    v_mfma_f32_16x16x32_bf16 v[180:183], a[60:63], v[40:43], v[180:183]
    s_add_u32 s69, s58, 0
    v_mfma_f32_16x16x32_bf16 v[184:187], a[104:107], v[36:39], v[184:187]
    v_mfma_f32_16x16x32_bf16 v[184:187], a[108:111], v[40:43], v[184:187]
    v_mfma_f32_16x16x32_bf16 v[188:191], a[152:155], v[36:39], v[188:191]
    buffer_load_dwordx4 v[28:31], v11, s[24:27], s69 offen offset:0 sc1
    v_mfma_f32_16x16x32_bf16 v[188:191], a[156:159], v[40:43], v[188:191]
    v_mfma_f32_16x16x32_bf16 v[192:195], a[200:203], v[36:39], v[192:195]
    v_mfma_f32_16x16x32_bf16 v[192:195], a[204:207], v[40:43], v[192:195]
    s_waitcnt vmcnt(8)
    v_mfma_f32_16x16x32_bf16 v[176:179], a[16:19], v[44:47], v[176:179]
    s_waitcnt vmcnt(7)
    v_mfma_f32_16x16x32_bf16 v[176:179], a[20:23], v[48:51], v[176:179]
    buffer_load_dwordx4 v[32:35], v11, s[24:27], s69 offen offset:1024 sc1
    v_mfma_f32_16x16x32_bf16 v[180:183], a[64:67], v[44:47], v[180:183]
    v_mfma_f32_16x16x32_bf16 v[180:183], a[68:71], v[48:51], v[180:183]
    v_mfma_f32_16x16x32_bf16 v[184:187], a[112:115], v[44:47], v[184:187]
    v_mfma_f32_16x16x32_bf16 v[184:187], a[116:119], v[48:51], v[184:187]
    v_mfma_f32_16x16x32_bf16 v[188:191], a[160:163], v[44:47], v[188:191]
    buffer_load_dwordx4 v[36:39], v11, s[24:27], s69 offen offset:2048 sc1
    v_mfma_f32_16x16x32_bf16 v[188:191], a[164:167], v[48:51], v[188:191]
    v_mfma_f32_16x16x32_bf16 v[192:195], a[208:211], v[44:47], v[192:195]
    v_mfma_f32_16x16x32_bf16 v[192:195], a[212:215], v[48:51], v[192:195]
    s_waitcnt vmcnt(8)
    v_mfma_f32_16x16x32_bf16 v[176:179], a[24:27], v[52:55], v[176:179]
    s_waitcnt vmcnt(7)
    v_mfma_f32_16x16x32_bf16 v[176:179], a[28:31], v[56:59], v[176:179]
    buffer_load_dwordx4 v[40:43], v11, s[24:27], s69 offen offset:3072 sc1
    v_mfma_f32_16x16x32_bf16 v[180:183], a[72:75], v[52:55], v[180:183]
    v_mfma_f32_16x16x32_bf16 v[180:183], a[76:79], v[56:59], v[180:183]
    s_add_u32 s69, s58, 4096
    v_mfma_f32_16x16x32_bf16 v[184:187], a[120:123], v[52:55], v[184:187]
    v_mfma_f32_16x16x32_bf16 v[184:187], a[124:127], v[56:59], v[184:187]
    v_mfma_f32_16x16x32_bf16 v[188:191], a[168:171], v[52:55], v[188:191]
    buffer_load_dwordx4 v[44:47], v11, s[24:27], s69 offen offset:0 sc1
    v_mfma_f32_16x16x32_bf16 v[188:191], a[172:175], v[56:59], v[188:191]
    v_mfma_f32_16x16x32_bf16 v[192:195], a[216:219], v[52:55], v[192:195]
    s_mov_b64 s[72:73], 0
    s_mov_b64 s[74:75], 0
    s_mov_b64 s[76:77], 0
    s_buffer_load_dwordx8 s[72:79], s[36:39], s63 offset:81920
    v_mfma_f32_16x16x32_bf16 v[192:195], a[220:223], v[56:59], v[192:195]
    s_waitcnt vmcnt(8)
    v_mfma_f32_16x16x32_bf16 v[176:179], a[32:35], v[60:63], v[176:179]
    s_waitcnt vmcnt(7)
    v_mfma_f32_16x16x32_bf16 v[176:179], a[36:39], v[64:67], v[176:179]
    buffer_load_dwordx4 v[48:51], v11, s[24:27], s69 offen offset:1024 sc1
    v_mfma_f32_16x16x32_bf16 v[180:183], a[80:83], v[60:63], v[180:183]
    v_mfma_f32_16x16x32_bf16 v[180:183], a[84:87], v[64:67], v[180:183]
    v_mfma_f32_16x16x32_bf16 v[184:187], a[128:131], v[60:63], v[184:187]
    v_mfma_f32_16x16x32_bf16 v[184:187], a[132:135], v[64:67], v[184:187]
    v_mfma_f32_16x16x32_bf16 v[188:191], a[176:179], v[60:63], v[188:191]
    buffer_load_dwordx4 v[52:55], v11, s[24:27], s69 offen offset:2048 sc1
    v_mfma_f32_16x16x32_bf16 v[188:191], a[180:183], v[64:67], v[188:191]
    v_mfma_f32_16x16x32_bf16 v[192:195], a[224:227], v[60:63], v[192:195]
    v_mfma_f32_16x16x32_bf16 v[192:195], a[228:231], v[64:67], v[192:195]
    s_waitcnt vmcnt(8)
    v_mfma_f32_16x16x32_bf16 v[176:179], a[40:43], v[68:71], v[176:179]
    s_waitcnt vmcnt(7)
    v_mfma_f32_16x16x32_bf16 v[176:179], a[44:47], v[72:75], v[176:179]
    buffer_load_dwordx4 v[56:59], v11, s[24:27], s69 offen offset:3072 sc1
    v_mfma_f32_16x16x32_bf16 v[180:183], a[88:91], v[68:71], v[180:183]
    v_mfma_f32_16x16x32_bf16 v[180:183], a[92:95], v[72:75], v[180:183]
    s_add_u32 s69, s58, 8192
    v_mfma_f32_16x16x32_bf16 v[184:187], a[136:139], v[68:71], v[184:187]
    v_mfma_f32_16x16x32_bf16 v[184:187], a[140:143], v[72:75], v[184:187]
    v_mfma_f32_16x16x32_bf16 v[188:191], a[184:187], v[68:71], v[188:191]
    buffer_load_dwordx4 v[60:63], v11, s[24:27], s69 offen offset:0 sc1
    v_mfma_f32_16x16x32_bf16 v[188:191], a[188:191], v[72:75], v[188:191]
    v_mfma_f32_16x16x32_bf16 v[192:195], a[232:235], v[68:71], v[192:195]
    v_mfma_f32_16x16x32_bf16 v[192:195], a[236:239], v[72:75], v[192:195]
    s_waitcnt vmcnt(8)
    v_mfma_f32_16x16x32_bf16 v[196:199], a[0:3], v[28:31], 0
    s_waitcnt vmcnt(7)
    v_mfma_f32_16x16x32_bf16 v[196:199], a[4:7], v[32:35], v[196:199]
    buffer_load_dwordx4 v[64:67], v11, s[24:27], s69 offen offset:1024 sc1
    v_mfma_f32_16x16x32_bf16 v[200:203], a[48:51], v[28:31], 0
    v_mfma_f32_16x16x32_bf16 v[200:203], a[52:55], v[32:35], v[200:203]
    v_mfma_f32_16x16x32_bf16 v[204:207], a[96:99], v[28:31], 0
    v_mfma_f32_16x16x32_bf16 v[204:207], a[100:103], v[32:35], v[204:207]
    ds_write_b128 v168, v[176:179] offset:0
    v_mfma_f32_16x16x32_bf16 v[208:211], a[144:147], v[28:31], 0
    buffer_load_dwordx4 v[68:71], v11, s[24:27], s69 offen offset:2048 sc1
    v_mfma_f32_16x16x32_bf16 v[208:211], a[148:151], v[32:35], v[208:211]
    v_mfma_f32_16x16x32_bf16 v[212:215], a[192:195], v[28:31], 0
    ds_write_b128 v168, v[180:183] offset:64
    v_mfma_f32_16x16x32_bf16 v[212:215], a[196:199], v[32:35], v[212:215]
    s_waitcnt vmcnt(8)
    v_mfma_f32_16x16x32_bf16 v[196:199], a[8:11], v[36:39], v[196:199]
    ds_write_b128 v168, v[184:187] offset:128
    s_waitcnt vmcnt(7)
    v_mfma_f32_16x16x32_bf16 v[196:199], a[12:15], v[40:43], v[196:199]
    buffer_load_dwordx4 v[72:75], v11, s[24:27], s69 offen offset:3072 sc1
    v_mfma_f32_16x16x32_bf16 v[200:203], a[56:59], v[36:39], v[200:203]
    s_cmp_eq_u64 s[72:73], s[52:53]
    s_cbranch_scc0 L_ph2_slow
    s_cmp_eq_u64 s[74:75], s[52:53]
    s_cbranch_scc0 L_ph2_slow
    s_cmp_eq_u64 s[76:77], s[52:53]
    s_cbranch_scc0 L_ph2_slow
L_ph2_out:
    v_mfma_f32_16x16x32_bf16 v[200:203], a[60:63], v[40:43], v[200:203]
    s_add_u32 s69, s59, 0
    v_mfma_f32_16x16x32_bf16 v[204:207], a[104:107], v[36:39], v[204:207]
    ds_write_b128 v168, v[188:191] offset:192
    v_mfma_f32_16x16x32_bf16 v[204:207], a[108:111], v[40:43], v[204:207]
    v_mfma_f32_16x16x32_bf16 v[208:211], a[152:155], v[36:39], v[208:211]
    buffer_load_dwordx4 v[28:31], v11, s[24:27], s69 offen offset:0 sc1
    v_mfma_f32_16x16x32_bf16 v[208:211], a[156:159], v[40:43], v[208:211]
    ds_write_b128 v168, v[192:195] offset:256
    v_mfma_f32_16x16x32_bf16 v[212:215], a[200:203], v[36:39], v[212:215]
    v_mfma_f32_16x16x32_bf16 v[212:215], a[204:207], v[40:43], v[212:215]
    s_waitcnt vmcnt(8)
    v_mfma_f32_16x16x32_bf16 v[196:199], a[16:19], v[44:47], v[196:199]
    s_waitcnt vmcnt(7)
    v_mfma_f32_16x16x32_bf16 v[196:199], a[20:23], v[48:51], v[196:199]
    buffer_load_dwordx4 v[32:35], v11, s[24:27], s69 offen offset:1024 sc1
    v_mfma_f32_16x16x32_bf16 v[200:203], a[64:67], v[44:47], v[200:203]
    s_waitcnt lgkmcnt(0)
    s_barrier
    v_mfma_f32_16x16x32_bf16 v[200:203], a[68:71], v[48:51], v[200:203]
    ds_read_b128 v[132:135], v169 offset:0
    v_mfma_f32_16x16x32_bf16 v[204:207], a[112:115], v[44:47], v[204:207]
    ds_read_b128 v[148:151], v169 offset:16
    v_mfma_f32_16x16x32_bf16 v[204:207], a[116:119], v[48:51], v[204:207]
    ds_read_b128 v[136:139], v169 offset:5376
    v_mfma_f32_16x16x32_bf16 v[208:211], a[160:163], v[44:47], v[208:211]
    buffer_load_dwordx4 v[36:39], v11, s[24:27], s69 offen offset:2048 sc1
    v_mfma_f32_16x16x32_bf16 v[208:211], a[164:167], v[48:51], v[208:211]
    ds_read_b128 v[152:155], v169 offset:5392
    v_mfma_f32_16x16x32_bf16 v[212:215], a[208:211], v[44:47], v[212:215]
    ds_read_b128 v[140:143], v169 offset:10752
    v_mfma_f32_16x16x32_bf16 v[212:215], a[212:215], v[48:51], v[212:215]
    ds_read_b128 v[156:159], v169 offset:10768
    s_waitcnt vmcnt(8)
    v_mfma_f32_16x16x32_bf16 v[196:199], a[24:27], v[52:55], v[196:199]
    ds_read_b128 v[144:147], v169 offset:16128
    s_waitcnt vmcnt(7)
    v_mfma_f32_16x16x32_bf16 v[196:199], a[28:31], v[56:59], v[196:199]
    buffer_load_dwordx4 v[40:43], v11, s[24:27], s69 offen offset:3072 sc1
    v_mfma_f32_16x16x32_bf16 v[200:203], a[72:75], v[52:55], v[200:203]
    ds_read_b128 v[160:163], v169 offset:16144
    v_mfma_f32_16x16x32_bf16 v[200:203], a[76:79], v[56:59], v[200:203]
    s_add_u32 s69, s59, 4096
    v_mfma_f32_16x16x32_bf16 v[204:207], a[120:123], v[52:55], v[204:207]
    v_mfma_f32_16x16x32_bf16 v[204:207], a[124:127], v[56:59], v[204:207]
    v_mfma_f32_16x16x32_bf16 v[208:211], a[168:171], v[52:55], v[208:211]
    buffer_load_dwordx4 v[44:47], v11, s[24:27], s69 offen offset:0 sc1
    v_mfma_f32_16x16x32_bf16 v[208:211], a[172:175], v[56:59], v[208:211]
    v_mfma_f32_16x16x32_bf16 v[212:215], a[216:219], v[52:55], v[212:215]
    s_waitcnt lgkmcnt(0)
    s_mov_b64 s[72:73], 0
    s_mov_b64 s[74:75], 0
    s_mov_b64 s[76:77], 0
    s_buffer_load_dwordx8 s[72:79], s[36:39], s64 offset:122880
    v_mfma_f32_16x16x32_bf16 v[212:215], a[220:223], v[56:59], v[212:215]
    v_add_f32 v132, v132, v136
    v_add_f32 v133, v133, v137
    s_waitcnt vmcnt(8)
    v_mfma_f32_16x16x32_bf16 v[196:199], a[32:35], v[60:63], v[196:199]
    v_add_f32 v134, v134, v138
    v_add_f32 v135, v135, v139
    s_waitcnt vmcnt(7)
    v_mfma_f32_16x16x32_bf16 v[196:199], a[36:39], v[64:67], v[196:199]
    buffer_load_dwordx4 v[48:51], v11, s[24:27], s69 offen offset:1024 sc1
    v_mfma_f32_16x16x32_bf16 v[200:203], a[80:83], v[60:63], v[200:203]
    v_add_f32 v148, v148, v152
    v_add_f32 v149, v149, v153
    v_mfma_f32_16x16x32_bf16 v[200:203], a[84:87], v[64:67], v[200:203]
    v_add_f32 v150, v150, v154
    v_add_f32 v151, v151, v155
    v_mfma_f32_16x16x32_bf16 v[204:207], a[128:131], v[60:63], v[204:207]
    v_add_f32 v132, v132, v140
    v_add_f32 v133, v133, v141
    v_mfma_f32_16x16x32_bf16 v[204:207], a[132:135], v[64:67], v[204:207]
    v_add_f32 v134, v134, v142
    v_add_f32 v135, v135, v143
    v_mfma_f32_16x16x32_bf16 v[208:211], a[176:179], v[60:63], v[208:211]
    buffer_load_dwordx4 v[52:55], v11, s[24:27], s69 offen offset:2048 sc1
    v_mfma_f32_16x16x32_bf16 v[208:211], a[180:183], v[64:67], v[208:211]
    v_add_f32 v148, v148, v156
    v_add_f32 v149, v149, v157
    v_mfma_f32_16x16x32_bf16 v[212:215], a[224:227], v[60:63], v[212:215]
    v_add_f32 v150, v150, v158
    v_add_f32 v151, v151, v159
    v_mfma_f32_16x16x32_bf16 v[212:215], a[228:231], v[64:67], v[212:215]
    v_add_f32 v132, v132, v144
    v_add_f32 v133, v133, v145
    s_waitcnt vmcnt(8)
    v_mfma_f32_16x16x32_bf16 v[196:199], a[40:43], v[68:71], v[196:199]
    v_add_f32 v134, v134, v146
    v_add_f32 v135, v135, v147
    s_waitcnt vmcnt(7)
    v_mfma_f32_16x16x32_bf16 v[196:199], a[44:47], v[72:75], v[196:199]
    buffer_load_dwordx4 v[56:59], v11, s[24:27], s69 offen offset:3072 sc1
    v_mfma_f32_16x16x32_bf16 v[200:203], a[88:91], v[68:71], v[200:203]
    v_add_f32 v148, v148, v160
    v_add_f32 v149, v149, v161
    v_mfma_f32_16x16x32_bf16 v[200:203], a[92:95], v[72:75], v[200:203]
    v_add_f32 v150, v150, v162
    v_add_f32 v151, v151, v163
    s_add_u32 s69, s59, 8192
    v_mfma_f32_16x16x32_bf16 v[204:207], a[136:139], v[68:71], v[204:207]
    v_cvt_pk_bf16_f32 v92, v132, v133
    v_cvt_pk_bf16_f32 v93, v134, v135
    v_mfma_f32_16x16x32_bf16 v[204:207], a[140:143], v[72:75], v[204:207]
    v_cvt_pk_bf16_f32 v94, v148, v149
    v_cvt_pk_bf16_f32 v95, v150, v151
    v_mfma_f32_16x16x32_bf16 v[208:211], a[184:187], v[68:71], v[208:211]
    buffer_load_dwordx4 v[60:63], v11, s[24:27], s69 offen offset:0 sc1
    v_mfma_f32_16x16x32_bf16 v[208:211], a[188:191], v[72:75], v[208:211]
    v_mfma_f32_16x16x32_bf16 v[212:215], a[232:235], v[68:71], v[212:215]
    v_mfma_f32_16x16x32_bf16 v[212:215], a[236:239], v[72:75], v[212:215]
    s_waitcnt vmcnt(8)
    v_mfma_f32_16x16x32_bf16 v[176:179], a[0:3], v[28:31], 0
    s_waitcnt vmcnt(7)
    v_mfma_f32_16x16x32_bf16 v[176:179], a[4:7], v[32:35], v[176:179]
    buffer_load_dwordx4 v[64:67], v11, s[24:27], s69 offen offset:1024 sc1
    v_mfma_f32_16x16x32_bf16 v[180:183], a[48:51], v[28:31], 0
    v_mfma_f32_16x16x32_bf16 v[180:183], a[52:55], v[32:35], v[180:183]
    v_mfma_f32_16x16x32_bf16 v[184:187], a[96:99], v[28:31], 0
    v_mfma_f32_16x16x32_bf16 v[184:187], a[100:103], v[32:35], v[184:187]
    ds_write_b128 v14, v[196:199] offset:0
    v_mfma_f32_16x16x32_bf16 v[188:191], a[144:147], v[28:31], 0
    buffer_load_dwordx4 v[68:71], v11, s[24:27], s69 offen offset:2048 sc1
    v_mfma_f32_16x16x32_bf16 v[188:191], a[148:151], v[32:35], v[188:191]
    v_mfma_f32_16x16x32_bf16 v[192:195], a[192:195], v[28:31], 0
    ds_write_b128 v14, v[200:203] offset:64
    v_mfma_f32_16x16x32_bf16 v[192:195], a[196:199], v[32:35], v[192:195]
    s_waitcnt vmcnt(8)
    v_mfma_f32_16x16x32_bf16 v[176:179], a[8:11], v[36:39], v[176:179]
    ds_write_b128 v14, v[204:207] offset:128
    s_waitcnt vmcnt(7)
    v_mfma_f32_16x16x32_bf16 v[176:179], a[12:15], v[40:43], v[176:179]
    buffer_load_dwordx4 v[72:75], v11, s[24:27], s69 offen offset:3072 sc1
    v_mfma_f32_16x16x32_bf16 v[180:183], a[56:59], v[36:39], v[180:183]
    s_cmp_eq_u64 s[72:73], s[52:53]
    s_cbranch_scc0 L_ph3_slow
    s_cmp_eq_u64 s[74:75], s[52:53]
    s_cbranch_scc0 L_ph3_slow
    s_cmp_eq_u64 s[76:77], s[52:53]
    s_cbranch_scc0 L_ph3_slow
L_ph3_out:
    v_mfma_f32_16x16x32_bf16 v[180:183], a[60:63], v[40:43], v[180:183]
    s_add_u32 s69, s60, 0
    v_mfma_f32_16x16x32_bf16 v[184:187], a[104:107], v[36:39], v[184:187]
    ds_write_b128 v14, v[208:211] offset:192
    v_mfma_f32_16x16x32_bf16 v[184:187], a[108:111], v[40:43], v[184:187]
    v_mfma_f32_16x16x32_bf16 v[188:191], a[152:155], v[36:39], v[188:191]
    buffer_load_dwordx4 v[28:31], v11, s[24:27], s69 offen offset:0 sc1
    v_mfma_f32_16x16x32_bf16 v[188:191], a[156:159], v[40:43], v[188:191]
    ds_write_b128 v14, v[212:215] offset:256
    v_mfma_f32_16x16x32_bf16 v[192:195], a[200:203], v[36:39], v[192:195]
    v_mfma_f32_16x16x32_bf16 v[192:195], a[204:207], v[40:43], v[192:195]
    s_waitcnt vmcnt(8)
    v_mfma_f32_16x16x32_bf16 v[176:179], a[16:19], v[44:47], v[176:179]
    s_waitcnt vmcnt(7)
    v_mfma_f32_16x16x32_bf16 v[176:179], a[20:23], v[48:51], v[176:179]
    buffer_load_dwordx4 v[32:35], v11, s[24:27], s69 offen offset:1024 sc1
    v_mfma_f32_16x16x32_bf16 v[180:183], a[64:67], v[44:47], v[180:183]
    s_waitcnt lgkmcnt(0)
    s_barrier
    v_mfma_f32_16x16x32_bf16 v[180:183], a[68:71], v[48:51], v[180:183]
    ds_read_b128 v[132:135], v15 offset:0
    v_mfma_f32_16x16x32_bf16 v[184:187], a[112:115], v[44:47], v[184:187]
    ds_read_b128 v[148:151], v15 offset:16
    v_mfma_f32_16x16x32_bf16 v[184:187], a[116:119], v[48:51], v[184:187]
    ds_read_b128 v[136:139], v15 offset:5376
    v_mfma_f32_16x16x32_bf16 v[188:191], a[160:163], v[44:47], v[188:191]
    buffer_load_dwordx4 v[36:39], v11, s[24:27], s69 offen offset:2048 sc1
    v_mfma_f32_16x16x32_bf16 v[188:191], a[164:167], v[48:51], v[188:191]
    ds_read_b128 v[152:155], v15 offset:5392
    v_mfma_f32_16x16x32_bf16 v[192:195], a[208:211], v[44:47], v[192:195]
    ds_read_b128 v[140:143], v15 offset:10752
    v_mfma_f32_16x16x32_bf16 v[192:195], a[212:215], v[48:51], v[192:195]
    ds_read_b128 v[156:159], v15 offset:10768
    s_waitcnt vmcnt(8)
    v_mfma_f32_16x16x32_bf16 v[176:179], a[24:27], v[52:55], v[176:179]
    ds_read_b128 v[144:147], v15 offset:16128
    s_waitcnt vmcnt(7)
    v_mfma_f32_16x16x32_bf16 v[176:179], a[28:31], v[56:59], v[176:179]
    buffer_load_dwordx4 v[40:43], v11, s[24:27], s69 offen offset:3072 sc1
    v_mfma_f32_16x16x32_bf16 v[180:183], a[72:75], v[52:55], v[180:183]
    ds_read_b128 v[160:163], v15 offset:16144
    v_mfma_f32_16x16x32_bf16 v[180:183], a[76:79], v[56:59], v[180:183]
    s_add_u32 s69, s60, 4096
    v_mfma_f32_16x16x32_bf16 v[184:187], a[120:123], v[52:55], v[184:187]
    v_mfma_f32_16x16x32_bf16 v[184:187], a[124:127], v[56:59], v[184:187]
    v_mfma_f32_16x16x32_bf16 v[188:191], a[168:171], v[52:55], v[188:191]
    buffer_load_dwordx4 v[44:47], v11, s[24:27], s69 offen offset:0 sc1
    v_mfma_f32_16x16x32_bf16 v[188:191], a[172:175], v[56:59], v[188:191]
    v_mfma_f32_16x16x32_bf16 v[192:195], a[216:219], v[52:55], v[192:195]
    s_waitcnt lgkmcnt(5)
    v_add_f32 v132, v132, v136
    v_add_f32 v133, v133, v137
    v_mfma_f32_16x16x32_bf16 v[192:195], a[220:223], v[56:59], v[192:195]
    v_add_f32 v134, v134, v138
    v_add_f32 v135, v135, v139
    s_waitcnt vmcnt(8)
    v_mfma_f32_16x16x32_bf16 v[176:179], a[32:35], v[60:63], v[176:179]
    s_waitcnt lgkmcnt(4)
    v_add_f32 v148, v148, v152
    v_add_f32 v149, v149, v153
    s_waitcnt vmcnt(7)
    v_mfma_f32_16x16x32_bf16 v[176:179], a[36:39], v[64:67], v[176:179]
    buffer_load_dwordx4 v[48:51], v11, s[24:27], s69 offen offset:1024 sc1
    v_mfma_f32_16x16x32_bf16 v[180:183], a[80:83], v[60:63], v[180:183]
    v_add_f32 v150, v150, v154
    v_add_f32 v151, v151, v155
    v_mfma_f32_16x16x32_bf16 v[180:183], a[84:87], v[64:67], v[180:183]
    s_waitcnt lgkmcnt(3)
    v_add_f32 v132, v132, v140
    v_add_f32 v133, v133, v141
    v_mfma_f32_16x16x32_bf16 v[184:187], a[128:131], v[60:63], v[184:187]
    v_add_f32 v134, v134, v142
    v_add_f32 v135, v135, v143
    v_mfma_f32_16x16x32_bf16 v[184:187], a[132:135], v[64:67], v[184:187]
    s_waitcnt lgkmcnt(2)
    v_add_f32 v148, v148, v156
    v_add_f32 v149, v149, v157
    v_mfma_f32_16x16x32_bf16 v[188:191], a[176:179], v[60:63], v[188:191]
    buffer_load_dwordx4 v[52:55], v11, s[24:27], s69 offen offset:2048 sc1
    v_mfma_f32_16x16x32_bf16 v[188:191], a[180:183], v[64:67], v[188:191]
    v_add_f32 v150, v150, v158
    v_add_f32 v151, v151, v159
    v_mfma_f32_16x16x32_bf16 v[192:195], a[224:227], v[60:63], v[192:195]
    s_waitcnt lgkmcnt(1)
    v_add_f32 v132, v132, v144
    v_add_f32 v133, v133, v145
    v_mfma_f32_16x16x32_bf16 v[192:195], a[228:231], v[64:67], v[192:195]
    v_add_f32 v134, v134, v146
    v_add_f32 v135, v135, v147
    s_waitcnt vmcnt(8)
    v_mfma_f32_16x16x32_bf16 v[176:179], a[40:43], v[68:71], v[176:179]
    s_waitcnt lgkmcnt(0)
    v_add_f32 v148, v148, v160
    v_add_f32 v149, v149, v161
    s_waitcnt vmcnt(7)
    v_mfma_f32_16x16x32_bf16 v[176:179], a[44:47], v[72:75], v[176:179]
    buffer_load_dwordx4 v[56:59], v11, s[24:27], s69 offen offset:3072 sc1
    v_mfma_f32_16x16x32_bf16 v[180:183], a[88:91], v[68:71], v[180:183]
    v_add_f32 v150, v150, v162
    v_add_f32 v151, v151, v163
    v_mfma_f32_16x16x32_bf16 v[180:183], a[92:95], v[72:75], v[180:183]
    v_cvt_pk_bf16_f32 v96, v132, v133
    v_cvt_pk_bf16_f32 v97, v134, v135
    s_add_u32 s69, s60, 8192
    v_mfma_f32_16x16x32_bf16 v[184:187], a[136:139], v[68:71], v[184:187]
    v_cvt_pk_bf16_f32 v98, v148, v149
    v_cvt_pk_bf16_f32 v99, v150, v151
    v_mfma_f32_16x16x32_bf16 v[184:187], a[140:143], v[72:75], v[184:187]
    v_mfma_f32_16x16x32_bf16 v[188:191], a[184:187], v[68:71], v[188:191]
    buffer_load_dwordx4 v[60:63], v11, s[24:27], s69 offen offset:0 sc1
    v_mfma_f32_16x16x32_bf16 v[188:191], a[188:191], v[72:75], v[188:191]
    v_mfma_f32_16x16x32_bf16 v[192:195], a[232:235], v[68:71], v[192:195]
    v_mfma_f32_16x16x32_bf16 v[192:195], a[236:239], v[72:75], v[192:195]
    s_waitcnt vmcnt(8)
    v_mfma_f32_16x16x32_bf16 v[196:199], a[0:3], v[28:31], 0
    s_waitcnt vmcnt(7)
    v_mfma_f32_16x16x32_bf16 v[196:199], a[4:7], v[32:35], v[196:199]
    buffer_load_dwordx4 v[64:67], v11, s[24:27], s69 offen offset:1024 sc1
    v_mfma_f32_16x16x32_bf16 v[200:203], a[48:51], v[28:31], 0
    v_mfma_f32_16x16x32_bf16 v[200:203], a[52:55], v[32:35], v[200:203]
    v_mfma_f32_16x16x32_bf16 v[204:207], a[96:99], v[28:31], 0
    v_mfma_f32_16x16x32_bf16 v[204:207], a[100:103], v[32:35], v[204:207]
    ds_write_b128 v168, v[176:179] offset:0
    v_mfma_f32_16x16x32_bf16 v[208:211], a[144:147], v[28:31], 0
    buffer_load_dwordx4 v[68:71], v11, s[24:27], s69 offen offset:2048 sc1
    v_mfma_f32_16x16x32_bf16 v[208:211], a[148:151], v[32:35], v[208:211]
    v_mfma_f32_16x16x32_bf16 v[212:215], a[192:195], v[28:31], 0
    ds_write_b128 v168, v[180:183] offset:64
    v_mfma_f32_16x16x32_bf16 v[212:215], a[196:199], v[32:35], v[212:215]
    s_waitcnt vmcnt(8)
    v_mfma_f32_16x16x32_bf16 v[196:199], a[8:11], v[36:39], v[196:199]
    ds_write_b128 v168, v[184:187] offset:128
    s_waitcnt vmcnt(7)
    v_mfma_f32_16x16x32_bf16 v[196:199], a[12:15], v[40:43], v[196:199]
    buffer_load_dwordx4 v[72:75], v11, s[24:27], s69 offen offset:3072 sc1
    v_mfma_f32_16x16x32_bf16 v[200:203], a[56:59], v[36:39], v[200:203]
    v_mfma_f32_16x16x32_bf16 v[200:203], a[60:63], v[40:43], v[200:203]
    ds_write_b128 v168, v[188:191] offset:192
    v_mfma_f32_16x16x32_bf16 v[204:207], a[104:107], v[36:39], v[204:207]
    v_mfma_f32_16x16x32_bf16 v[204:207], a[108:111], v[40:43], v[204:207]
    ds_write_b128 v168, v[192:195] offset:256
    v_mfma_f32_16x16x32_bf16 v[208:211], a[152:155], v[36:39], v[208:211]
    s_mov_b32 exec_hi, 0xff
    buffer_store_dwordx4 v[92:95], v16, s[20:23], s65 offen sc1
    s_mov_b32 exec_hi, -1
    v_mfma_f32_16x16x32_bf16 v[208:211], a[156:159], v[40:43], v[208:211]
    v_mfma_f32_16x16x32_bf16 v[212:215], a[200:203], v[36:39], v[212:215]
    v_mfma_f32_16x16x32_bf16 v[212:215], a[204:207], v[40:43], v[212:215]
    s_waitcnt vmcnt(8)
    v_mfma_f32_16x16x32_bf16 v[196:199], a[16:19], v[44:47], v[196:199]
    s_waitcnt lgkmcnt(0)
    s_barrier
    s_waitcnt vmcnt(7)
    v_mfma_f32_16x16x32_bf16 v[196:199], a[20:23], v[48:51], v[196:199]
    s_mov_b32 exec_hi, 0xff
    buffer_store_dwordx4 v[96:99], v16, s[20:23], s66 offen sc1
    s_mov_b32 exec_hi, -1
    v_mfma_f32_16x16x32_bf16 v[200:203], a[64:67], v[44:47], v[200:203]
    ds_read_b128 v[132:135], v169 offset:0
    v_mfma_f32_16x16x32_bf16 v[200:203], a[68:71], v[48:51], v[200:203]
    ds_read_b128 v[148:151], v169 offset:16
    v_mfma_f32_16x16x32_bf16 v[204:207], a[112:115], v[44:47], v[204:207]
    ds_read_b128 v[136:139], v169 offset:5376
    v_mfma_f32_16x16x32_bf16 v[204:207], a[116:119], v[48:51], v[204:207]
    ds_read_b128 v[152:155], v169 offset:5392
    v_mfma_f32_16x16x32_bf16 v[208:211], a[160:163], v[44:47], v[208:211]
    ds_read_b128 v[140:143], v169 offset:10752
    v_mfma_f32_16x16x32_bf16 v[208:211], a[164:167], v[48:51], v[208:211]
    ds_read_b128 v[156:159], v169 offset:10768
    v_mfma_f32_16x16x32_bf16 v[212:215], a[208:211], v[44:47], v[212:215]
    ds_read_b128 v[144:147], v169 offset:16128
    v_mfma_f32_16x16x32_bf16 v[212:215], a[212:215], v[48:51], v[212:215]
    ds_read_b128 v[160:163], v169 offset:16144
    s_waitcnt vmcnt(7)
    v_mfma_f32_16x16x32_bf16 v[196:199], a[24:27], v[52:55], v[196:199]
    s_waitcnt vmcnt(6)
    v_mfma_f32_16x16x32_bf16 v[196:199], a[28:31], v[56:59], v[196:199]
    v_mfma_f32_16x16x32_bf16 v[200:203], a[72:75], v[52:55], v[200:203]
    v_mfma_f32_16x16x32_bf16 v[200:203], a[76:79], v[56:59], v[200:203]
    v_mfma_f32_16x16x32_bf16 v[204:207], a[120:123], v[52:55], v[204:207]
    s_waitcnt lgkmcnt(5)
    v_add_f32 v132, v132, v136
    v_add_f32 v133, v133, v137
    v_mfma_f32_16x16x32_bf16 v[204:207], a[124:127], v[56:59], v[204:207]
    v_add_f32 v134, v134, v138
    v_add_f32 v135, v135, v139
    v_mfma_f32_16x16x32_bf16 v[208:211], a[168:171], v[52:55], v[208:211]
    s_waitcnt lgkmcnt(4)
    v_add_f32 v148, v148, v152
    v_add_f32 v149, v149, v153
    v_mfma_f32_16x16x32_bf16 v[208:211], a[172:175], v[56:59], v[208:211]
    v_add_f32 v150, v150, v154
    v_add_f32 v151, v151, v155
    v_mfma_f32_16x16x32_bf16 v[212:215], a[216:219], v[52:55], v[212:215]
    s_waitcnt lgkmcnt(3)
    v_add_f32 v132, v132, v140
    v_add_f32 v133, v133, v141
    v_mfma_f32_16x16x32_bf16 v[212:215], a[220:223], v[56:59], v[212:215]
    v_add_f32 v134, v134, v142
    v_add_f32 v135, v135, v143
    s_waitcnt vmcnt(5)
    v_mfma_f32_16x16x32_bf16 v[196:199], a[32:35], v[60:63], v[196:199]
    s_waitcnt lgkmcnt(2)
    v_add_f32 v148, v148, v156
    v_add_f32 v149, v149, v157
    s_waitcnt vmcnt(4)
    v_mfma_f32_16x16x32_bf16 v[196:199], a[36:39], v[64:67], v[196:199]
    v_add_f32 v150, v150, v158
    v_add_f32 v151, v151, v159
    s_waitcnt vmcnt(3)
    v_mfma_f32_16x16x32_bf16 v[196:199], a[40:43], v[68:71], v[196:199]
    s_waitcnt lgkmcnt(1)
    v_add_f32 v132, v132, v144
    v_add_f32 v133, v133, v145
    s_waitcnt vmcnt(2)
    v_mfma_f32_16x16x32_bf16 v[196:199], a[44:47], v[72:75], v[196:199]
    v_add_f32 v134, v134, v146
    v_add_f32 v135, v135, v147
    v_mfma_f32_16x16x32_bf16 v[200:203], a[80:83], v[60:63], v[200:203]
    s_waitcnt lgkmcnt(0)
    v_add_f32 v148, v148, v160
    v_add_f32 v149, v149, v161
    v_mfma_f32_16x16x32_bf16 v[200:203], a[84:87], v[64:67], v[200:203]
    v_add_f32 v150, v150, v162
    v_add_f32 v151, v151, v163
    v_mfma_f32_16x16x32_bf16 v[200:203], a[88:91], v[68:71], v[200:203]
    v_cvt_pk_bf16_f32 v100, v132, v133
    v_cvt_pk_bf16_f32 v101, v134, v135
    v_mfma_f32_16x16x32_bf16 v[200:203], a[92:95], v[72:75], v[200:203]
    v_cvt_pk_bf16_f32 v102, v148, v149
    v_cvt_pk_bf16_f32 v103, v150, v151
    v_mfma_f32_16x16x32_bf16 v[204:207], a[128:131], v[60:63], v[204:207]
    s_mov_b32 exec_hi, 0xff
    buffer_store_dwordx4 v[100:103], v16, s[20:23], s67 offen sc1
    s_mov_b32 exec_hi, -1
    v_mfma_f32_16x16x32_bf16 v[204:207], a[132:135], v[64:67], v[204:207]
    v_mfma_f32_16x16x32_bf16 v[204:207], a[136:139], v[68:71], v[204:207]
    ds_write_b128 v14, v[196:199] offset:0
    v_mfma_f32_16x16x32_bf16 v[204:207], a[140:143], v[72:75], v[204:207]
    v_mfma_f32_16x16x32_bf16 v[208:211], a[176:179], v[60:63], v[208:211]
    v_mfma_f32_16x16x32_bf16 v[208:211], a[180:183], v[64:67], v[208:211]
    v_mfma_f32_16x16x32_bf16 v[208:211], a[184:187], v[68:71], v[208:211]
    ds_write_b128 v14, v[200:203] offset:64
    v_mfma_f32_16x16x32_bf16 v[208:211], a[188:191], v[72:75], v[208:211]
    v_mfma_f32_16x16x32_bf16 v[212:215], a[224:227], v[60:63], v[212:215]
    v_mfma_f32_16x16x32_bf16 v[212:215], a[228:231], v[64:67], v[212:215]
    v_mfma_f32_16x16x32_bf16 v[212:215], a[232:235], v[68:71], v[212:215]
    ds_write_b128 v14, v[204:207] offset:128
    v_mfma_f32_16x16x32_bf16 v[212:215], a[236:239], v[72:75], v[212:215]
    s_nop 3
    ds_write_b128 v14, v[208:211] offset:192
    s_nop 2
    ds_write_b128 v14, v[212:215] offset:256
    s_waitcnt lgkmcnt(0)
    s_barrier
    ds_read_b128 v[132:135], v15 offset:0
    ds_read_b128 v[148:151], v15 offset:16
    ds_read_b128 v[136:139], v15 offset:5376
    ds_read_b128 v[152:155], v15 offset:5392
    ds_read_b128 v[140:143], v15 offset:10752
    ds_read_b128 v[156:159], v15 offset:10768
    ds_read_b128 v[144:147], v15 offset:16128
    ds_read_b128 v[160:163], v15 offset:16144
    s_waitcnt lgkmcnt(5)
    v_add_f32 v132, v132, v136
    v_add_f32 v133, v133, v137
    v_add_f32 v134, v134, v138
    v_add_f32 v135, v135, v139
    s_waitcnt lgkmcnt(4)
    v_add_f32 v148, v148, v152
    v_add_f32 v149, v149, v153
    v_add_f32 v150, v150, v154
    v_add_f32 v151, v151, v155
    s_waitcnt lgkmcnt(3)
    v_add_f32 v132, v132, v140
    v_add_f32 v133, v133, v141
    v_add_f32 v134, v134, v142
    v_add_f32 v135, v135, v143
    s_waitcnt lgkmcnt(2)
    v_add_f32 v148, v148, v156
    v_add_f32 v149, v149, v157
    v_add_f32 v150, v150, v158
    v_add_f32 v151, v151, v159
    s_waitcnt lgkmcnt(1)
    v_add_f32 v132, v132, v144
    v_add_f32 v133, v133, v145
    v_add_f32 v134, v134, v146
    v_add_f32 v135, v135, v147
    s_waitcnt lgkmcnt(0)
    v_add_f32 v148, v148, v160
    v_add_f32 v149, v149, v161
    v_add_f32 v150, v150, v162
    v_add_f32 v151, v151, v163
    v_cvt_pk_bf16_f32 v104, v132, v133
    v_cvt_pk_bf16_f32 v105, v134, v135
    v_cvt_pk_bf16_f32 v106, v148, v149
    v_cvt_pk_bf16_f32 v107, v150, v151
    s_mov_b32 exec_hi, 0xff
    buffer_store_dwordx4 v[104:107], v16, s[20:23], s68 offen sc1
    s_mov_b32 exec_hi, -1
L_end_standalone__glu_gated_swiglu__prompt_kernel:
    s_endpgm
L_spare:
    s_mov_b32 s34, 256
    s_mov_b32 s35, 0x20000
    s_lshl_b32 s72, s45, 1
    s_add_u32 s72, s72, s46
    s_sub_u32 s72, s72, 30
    s_lshr_b32 s48, s72, 2
    s_mul_i32 s48, s48, 384
    v_lshrrev_b32 v4, 3, v1
    v_add_u32 v4, s48, v4
    v_mul_u32_u24 v17, 1280, v4
    v_bfe_u32 v4, v1, 4, 1
    v_lshlrev_b32 v4, 1, v4
    v_and_b32 v5, 7, v1
    v_xor_b32 v4, v4, v5
    v_lshl_add_u32 v17, v4, 4, v17
    v_xor_b32 v4, 64, v17
    v_add_u32 v18, 9216, v4
    v_add_u32 v19, 18432, v17
    v_add_u32 v20, 27648, v4
    s_and_b32 s51, s72, 3
    s_lshl_b32 s51, s51, 2
    s_add_u32 s51, s51, s44
    s_add_u32 s47, s51, 0
    s_mul_i32 s48, s47, 205
    s_lshr_b32 s48, s48, 11
    s_mul_i32 s49, s48, 10
    s_sub_u32 s49, s47, s49
    s_mul_i32 s73, s48, 40960
    s_lshl_b32 s50, s49, 7
    s_add_u32 s73, s73, s50
    s_mul_i32 s81, s49, 196608
    s_lshl_b32 s50, s48, 10
    s_add_u32 s81, s81, s50
    s_add_u32 s47, s51, 16
    s_mul_i32 s48, s47, 205
    s_lshr_b32 s48, s48, 11
    s_mul_i32 s49, s48, 10
    s_sub_u32 s49, s47, s49
    s_mul_i32 s74, s48, 40960
    s_lshl_b32 s50, s49, 7
    s_add_u32 s74, s74, s50
    s_mul_i32 s82, s49, 196608
    s_lshl_b32 s50, s48, 10
    s_add_u32 s82, s82, s50
    s_add_u32 s47, s51, 32
    s_mul_i32 s48, s47, 205
    s_lshr_b32 s48, s48, 11
    s_mul_i32 s49, s48, 10
    s_sub_u32 s49, s47, s49
    s_mul_i32 s75, s48, 40960
    s_lshl_b32 s50, s49, 7
    s_add_u32 s75, s75, s50
    s_mul_i32 s83, s49, 196608
    s_lshl_b32 s50, s48, 10
    s_add_u32 s83, s83, s50
    s_lshl_b32 s89, s44, 15
    s_waitcnt lgkmcnt(0)
    s_mov_b32 s18, 1966080
    s_mov_b32 s19, 0x20000
    s_mov_b32 s22, 2621440
    s_mov_b32 s23, 0x20000
    s_mov_b32 s26, 6291456
    s_mov_b32 s27, 0x20000
    s_mov_b32 s30, 1966080
    s_mov_b32 s31, 0x20000
    s_mov_b32 s38, 262144
    s_mov_b32 s39, 0x20000
    s_add_u32 s28, s28, 8388608
    s_addc_u32 s29, s29, 0
    s_add_u32 s36, s36, 12582912
    s_addc_u32 s37, s37, 0
    s_add_u32 m0, s89, 0
    s_nop 0
    buffer_load_dwordx4 v17, s[16:19], s73 offen offset:0 lds
    buffer_load_dwordx4 v18, s[16:19], s73 offen offset:1024 lds
    buffer_load_dwordx4 v19, s[16:19], s73 offen offset:2048 lds
    buffer_load_dwordx4 v20, s[16:19], s73 offen offset:3072 lds
    s_add_u32 m0, s89, 4096
    s_nop 0
    buffer_load_dwordx4 v17, s[16:19], s74 offen offset:0 lds
    buffer_load_dwordx4 v18, s[16:19], s74 offen offset:1024 lds
    buffer_load_dwordx4 v19, s[16:19], s74 offen offset:2048 lds
    buffer_load_dwordx4 v20, s[16:19], s74 offen offset:3072 lds
    s_add_u32 m0, s89, 8192
    s_nop 0
    buffer_load_dwordx4 v17, s[16:19], s75 offen offset:0 lds
    buffer_load_dwordx4 v18, s[16:19], s75 offen offset:1024 lds
    buffer_load_dwordx4 v19, s[16:19], s75 offen offset:2048 lds
    buffer_load_dwordx4 v20, s[16:19], s75 offen offset:3072 lds
    s_add_u32 s47, s51, 48
    s_mul_i32 s48, s47, 205
    s_lshr_b32 s48, s48, 11
    s_mul_i32 s49, s48, 10
    s_sub_u32 s49, s47, s49
    s_mul_i32 s76, s48, 40960
    s_lshl_b32 s50, s49, 7
    s_add_u32 s76, s76, s50
    s_mul_i32 s84, s49, 196608
    s_lshl_b32 s50, s48, 10
    s_add_u32 s84, s84, s50
    s_add_u32 s47, s51, 64
    s_mul_i32 s48, s47, 205
    s_lshr_b32 s48, s48, 11
    s_mul_i32 s49, s48, 10
    s_sub_u32 s49, s47, s49
    s_mul_i32 s77, s48, 40960
    s_lshl_b32 s50, s49, 7
    s_add_u32 s77, s77, s50
    s_mul_i32 s85, s49, 196608
    s_lshl_b32 s50, s48, 10
    s_add_u32 s85, s85, s50
    s_add_u32 s47, s51, 80
    s_mul_i32 s48, s47, 205
    s_lshr_b32 s48, s48, 11
    s_mul_i32 s49, s48, 10
    s_sub_u32 s49, s47, s49
    s_mul_i32 s78, s48, 40960
    s_lshl_b32 s50, s49, 7
    s_add_u32 s78, s78, s50
    s_mul_i32 s86, s49, 196608
    s_lshl_b32 s50, s48, 10
    s_add_u32 s86, s86, s50
    s_add_u32 s47, s51, 96
    s_mul_i32 s48, s47, 205
    s_lshr_b32 s48, s48, 11
    s_mul_i32 s49, s48, 10
    s_sub_u32 s49, s47, s49
    s_mul_i32 s79, s48, 40960
    s_lshl_b32 s50, s49, 7
    s_add_u32 s79, s79, s50
    s_mul_i32 s87, s49, 196608
    s_lshl_b32 s50, s48, 10
    s_add_u32 s87, s87, s50
    s_add_u32 s47, s51, 112
    s_mul_i32 s48, s47, 205
    s_lshr_b32 s48, s48, 11
    s_mul_i32 s49, s48, 10
    s_sub_u32 s49, s47, s49
    s_mul_i32 s80, s48, 40960
    s_lshl_b32 s50, s49, 7
    s_add_u32 s80, s80, s50
    s_mul_i32 s88, s49, 196608
    s_lshl_b32 s50, s48, 10
    s_add_u32 s88, s88, s50
    s_cmp_ge_u32 s47, 120
    s_cselect_b32 s80, 0x40000000, s80
    s_cselect_b32 s88, 0x40000000, s88
    v_bfe_u32 v4, v1, 5, 1
    v_mul_u32_u24 v21, 2048, v4
    v_bfe_u32 v4, v1, 4, 1
    v_mul_u32_u24 v5, 1024, v4
    v_add_u32 v21, v21, v5
    v_lshlrev_b32 v5, 2, v4
    v_bfe_u32 v4, v1, 3, 1
    v_lshl_add_u32 v5, v4, 1, v5
    v_bfe_u32 v4, v1, 1, 1
    v_xor_b32 v4, v4, v5
    v_lshl_add_u32 v21, v4, 4, v21
    v_bfe_u32 v4, v1, 2, 2
    v_lshl_add_u32 v21, v4, 7, v21
    v_and_b32 v4, 1, v1
    v_lshl_add_u32 v21, v4, 3, v21
    v_add_u32 v21, s89, v21
    v_xor_b32 v22, 32, v21
    v_xor_b32 v23, 64, v21
    v_xor_b32 v24, 96, v21
    s_lshr_b32 s48, s72, 2
    s_mul_i32 s48, s48, 12288
    v_lshlrev_b32 v25, 4, v1
    v_add_u32 v25, s48, v25
    v_add_u32 v26, 49152, v25
    v_add_u32 v27, 98304, v25
    v_add_u32 v28, 147456, v25
    s_lshr_b32 s47, s72, 2
    s_lshl_b32 s47, s47, 9
    s_and_b32 s51, s72, 3
    s_mul_i32 s51, s51, 4
    s_add_u32 s51, s51, s47
    s_add_u32 s51, s51, 196608
    s_waitcnt vmcnt(8)
    ds_read_b64_tr_b16 v[32:33], v21 offset:0
    ds_read_b64_tr_b16 v[34:35], v21 offset:512
    ds_read_b64_tr_b16 v[36:37], v22 offset:0
    ds_read_b64_tr_b16 v[38:39], v22 offset:512
    ds_read_b64_tr_b16 v[40:41], v23 offset:0
    ds_read_b64_tr_b16 v[42:43], v23 offset:512
    ds_read_b64_tr_b16 v[44:45], v24 offset:0
    ds_read_b64_tr_b16 v[46:47], v24 offset:512
    s_add_u32 m0, s89, 12288
    s_nop 0
    buffer_load_dwordx4 v17, s[16:19], s76 offen offset:0 lds
    buffer_load_dwordx4 v18, s[16:19], s76 offen offset:1024 lds
    buffer_load_dwordx4 v19, s[16:19], s76 offen offset:2048 lds
    buffer_load_dwordx4 v20, s[16:19], s76 offen offset:3072 lds
    s_waitcnt lgkmcnt(6)
    buffer_store_dwordx4 v[32:35], v25, s[28:31], s81 offen sc1
    s_waitcnt lgkmcnt(4)
    buffer_store_dwordx4 v[36:39], v26, s[28:31], s81 offen sc1
    s_waitcnt lgkmcnt(2)
    buffer_store_dwordx4 v[40:43], v27, s[28:31], s81 offen sc1
    s_waitcnt lgkmcnt(0)
    buffer_store_dwordx4 v[44:47], v28, s[28:31], s81 offen sc1
    s_waitcnt vmcnt(12)
    ds_read_b64_tr_b16 v[48:49], v21 offset:4096
    ds_read_b64_tr_b16 v[50:51], v21 offset:4608
    ds_read_b64_tr_b16 v[52:53], v22 offset:4096
    ds_read_b64_tr_b16 v[54:55], v22 offset:4608
    ds_read_b64_tr_b16 v[56:57], v23 offset:4096
    ds_read_b64_tr_b16 v[58:59], v23 offset:4608
    ds_read_b64_tr_b16 v[60:61], v24 offset:4096
    ds_read_b64_tr_b16 v[62:63], v24 offset:4608
    s_add_u32 m0, s89, 16384
    s_nop 0
    buffer_load_dwordx4 v17, s[16:19], s77 offen offset:0 lds
    buffer_load_dwordx4 v18, s[16:19], s77 offen offset:1024 lds
    buffer_load_dwordx4 v19, s[16:19], s77 offen offset:2048 lds
    buffer_load_dwordx4 v20, s[16:19], s77 offen offset:3072 lds
    s_waitcnt lgkmcnt(6)
    buffer_store_dwordx4 v[48:51], v25, s[28:31], s82 offen sc1
    s_waitcnt lgkmcnt(4)
    buffer_store_dwordx4 v[52:55], v26, s[28:31], s82 offen sc1
    s_waitcnt lgkmcnt(2)
    buffer_store_dwordx4 v[56:59], v27, s[28:31], s82 offen sc1
    s_waitcnt lgkmcnt(0)
    buffer_store_dwordx4 v[60:63], v28, s[28:31], s82 offen sc1
    s_waitcnt vmcnt(16)
    ds_read_b64_tr_b16 v[32:33], v21 offset:8192
    ds_read_b64_tr_b16 v[34:35], v21 offset:8704
    ds_read_b64_tr_b16 v[36:37], v22 offset:8192
    ds_read_b64_tr_b16 v[38:39], v22 offset:8704
    ds_read_b64_tr_b16 v[40:41], v23 offset:8192
    ds_read_b64_tr_b16 v[42:43], v23 offset:8704
    ds_read_b64_tr_b16 v[44:45], v24 offset:8192
    ds_read_b64_tr_b16 v[46:47], v24 offset:8704
    s_add_u32 m0, s89, 20480
    s_nop 0
    buffer_load_dwordx4 v17, s[16:19], s78 offen offset:0 lds
    buffer_load_dwordx4 v18, s[16:19], s78 offen offset:1024 lds
    buffer_load_dwordx4 v19, s[16:19], s78 offen offset:2048 lds
    buffer_load_dwordx4 v20, s[16:19], s78 offen offset:3072 lds
    s_waitcnt lgkmcnt(6)
    buffer_store_dwordx4 v[32:35], v25, s[28:31], s83 offen sc1
    s_waitcnt lgkmcnt(4)
    buffer_store_dwordx4 v[36:39], v26, s[28:31], s83 offen sc1
    s_waitcnt lgkmcnt(2)
    buffer_store_dwordx4 v[40:43], v27, s[28:31], s83 offen sc1
    s_waitcnt lgkmcnt(0)
    buffer_store_dwordx4 v[44:47], v28, s[28:31], s83 offen sc1
    s_buffer_load_dword s52, s[32:35], 0
    s_waitcnt vmcnt(20)
    ds_read_b64_tr_b16 v[48:49], v21 offset:12288
    ds_read_b64_tr_b16 v[50:51], v21 offset:12800
    ds_read_b64_tr_b16 v[52:53], v22 offset:12288
    ds_read_b64_tr_b16 v[54:55], v22 offset:12800
    ds_read_b64_tr_b16 v[56:57], v23 offset:12288
    ds_read_b64_tr_b16 v[58:59], v23 offset:12800
    ds_read_b64_tr_b16 v[60:61], v24 offset:12288
    ds_read_b64_tr_b16 v[62:63], v24 offset:12800
    s_add_u32 m0, s89, 24576
    s_nop 0
    buffer_load_dwordx4 v17, s[16:19], s79 offen offset:0 lds
    buffer_load_dwordx4 v18, s[16:19], s79 offen offset:1024 lds
    buffer_load_dwordx4 v19, s[16:19], s79 offen offset:2048 lds
    buffer_load_dwordx4 v20, s[16:19], s79 offen offset:3072 lds
    s_waitcnt lgkmcnt(6)
    buffer_store_dwordx4 v[48:51], v25, s[28:31], s84 offen sc1
    s_waitcnt lgkmcnt(4)
    buffer_store_dwordx4 v[52:55], v26, s[28:31], s84 offen sc1
    s_waitcnt lgkmcnt(2)
    buffer_store_dwordx4 v[56:59], v27, s[28:31], s84 offen sc1
    s_waitcnt lgkmcnt(0)
    buffer_store_dwordx4 v[60:63], v28, s[28:31], s84 offen sc1
    s_waitcnt vmcnt(8)
    s_waitcnt lgkmcnt(0)
    s_cmp_eq_u32 s52, 0
    s_cbranch_scc1 L_tok2_slow
L_tok2_ok:
    v_mov_b32 v8, s52
    s_mov_b32 s53, s52
    s_barrier
    s_cmp_lg_u32 s44, 0
    s_cbranch_scc1 L_r3
    s_mov_b64 exec, 1
    buffer_store_dword v8, off, s[36:39], s51 sc1
    s_mov_b64 exec, -1
L_r3:
    s_add_u32 s51, s51, 2048
    ds_read_b64_tr_b16 v[32:33], v21 offset:16384
    ds_read_b64_tr_b16 v[34:35], v21 offset:16896
    ds_read_b64_tr_b16 v[36:37], v22 offset:16384
    ds_read_b64_tr_b16 v[38:39], v22 offset:16896
    ds_read_b64_tr_b16 v[40:41], v23 offset:16384
    ds_read_b64_tr_b16 v[42:43], v23 offset:16896
    ds_read_b64_tr_b16 v[44:45], v24 offset:16384
    ds_read_b64_tr_b16 v[46:47], v24 offset:16896
    s_add_u32 m0, s89, 28672
    s_nop 0
    buffer_load_dwordx4 v17, s[16:19], s80 offen offset:0 lds
    buffer_load_dwordx4 v18, s[16:19], s80 offen offset:1024 lds
    buffer_load_dwordx4 v19, s[16:19], s80 offen offset:2048 lds
    buffer_load_dwordx4 v20, s[16:19], s80 offen offset:3072 lds
    s_waitcnt lgkmcnt(6)
    buffer_store_dwordx4 v[32:35], v25, s[28:31], s85 offen sc1
    s_waitcnt lgkmcnt(4)
    buffer_store_dwordx4 v[36:39], v26, s[28:31], s85 offen sc1
    s_waitcnt lgkmcnt(2)
    buffer_store_dwordx4 v[40:43], v27, s[28:31], s85 offen sc1
    s_waitcnt lgkmcnt(0)
    buffer_store_dwordx4 v[44:47], v28, s[28:31], s85 offen sc1
    ds_read_b64_tr_b16 v[48:49], v21 offset:20480
    ds_read_b64_tr_b16 v[50:51], v21 offset:20992
    ds_read_b64_tr_b16 v[52:53], v22 offset:20480
    ds_read_b64_tr_b16 v[54:55], v22 offset:20992
    ds_read_b64_tr_b16 v[56:57], v23 offset:20480
    ds_read_b64_tr_b16 v[58:59], v23 offset:20992
    ds_read_b64_tr_b16 v[60:61], v24 offset:20480
    ds_read_b64_tr_b16 v[62:63], v24 offset:20992
    s_waitcnt lgkmcnt(6)
    buffer_store_dwordx4 v[48:51], v25, s[28:31], s86 offen sc1
    s_waitcnt lgkmcnt(4)
    buffer_store_dwordx4 v[52:55], v26, s[28:31], s86 offen sc1
    s_waitcnt lgkmcnt(2)
    buffer_store_dwordx4 v[56:59], v27, s[28:31], s86 offen sc1
    s_waitcnt lgkmcnt(0)
    buffer_store_dwordx4 v[60:63], v28, s[28:31], s86 offen sc1
    s_waitcnt vmcnt(4)
    s_barrier
    s_cmp_lg_u32 s44, 0
    s_cbranch_scc1 L_r5
    s_mov_b64 exec, 1
    buffer_store_dword v8, off, s[36:39], s51 sc1
    s_mov_b64 exec, -1
L_r5:
    s_add_u32 s51, s51, 2048
    ds_read_b64_tr_b16 v[32:33], v21 offset:24576
    ds_read_b64_tr_b16 v[34:35], v21 offset:25088
    ds_read_b64_tr_b16 v[36:37], v22 offset:24576
    ds_read_b64_tr_b16 v[38:39], v22 offset:25088
    ds_read_b64_tr_b16 v[40:41], v23 offset:24576
    ds_read_b64_tr_b16 v[42:43], v23 offset:25088
    ds_read_b64_tr_b16 v[44:45], v24 offset:24576
    ds_read_b64_tr_b16 v[46:47], v24 offset:25088
    s_waitcnt lgkmcnt(6)
    buffer_store_dwordx4 v[32:35], v25, s[28:31], s87 offen sc1
    s_waitcnt lgkmcnt(4)
    buffer_store_dwordx4 v[36:39], v26, s[28:31], s87 offen sc1
    s_waitcnt lgkmcnt(2)
    buffer_store_dwordx4 v[40:43], v27, s[28:31], s87 offen sc1
    s_waitcnt lgkmcnt(0)
    buffer_store_dwordx4 v[44:47], v28, s[28:31], s87 offen sc1
    ds_read_b64_tr_b16 v[48:49], v21 offset:28672
    ds_read_b64_tr_b16 v[50:51], v21 offset:29184
    ds_read_b64_tr_b16 v[52:53], v22 offset:28672
    ds_read_b64_tr_b16 v[54:55], v22 offset:29184
    ds_read_b64_tr_b16 v[56:57], v23 offset:28672
    ds_read_b64_tr_b16 v[58:59], v23 offset:29184
    ds_read_b64_tr_b16 v[60:61], v24 offset:28672
    ds_read_b64_tr_b16 v[62:63], v24 offset:29184
    s_waitcnt lgkmcnt(6)
    buffer_store_dwordx4 v[48:51], v25, s[28:31], s88 offen sc1
    s_waitcnt lgkmcnt(4)
    buffer_store_dwordx4 v[52:55], v26, s[28:31], s88 offen sc1
    s_waitcnt lgkmcnt(2)
    buffer_store_dwordx4 v[56:59], v27, s[28:31], s88 offen sc1
    s_waitcnt lgkmcnt(0)
    buffer_store_dwordx4 v[60:63], v28, s[28:31], s88 offen sc1
    s_and_b32 s54, s45, 3
    s_lshl_b32 s54, s54, 3
    s_and_b32 s47, s46, 7
    s_add_u32 s54, s54, s47
    s_lshr_b32 s55, s45, 2
    s_lshl_b32 s55, s55, 2
    s_lshr_b32 s47, s46, 3
    s_add_u32 s55, s55, s47
    s_mul_i32 s47, s44, 12288
    v_lshlrev_b32 v4, 4, v1
    v_add_u32 v11, s47, v4
    s_mul_i32 s48, s55, 196608
    v_add_u32 v10, s48, v11
    v_min_u32 v4, 3, v1
    v_mul_u32_u24 v12, 4, v4
    s_lshl_b32 s71, s44, 9
    s_add_u32 s71, s71, 196608
    v_min_u32 v4, 5, v1
    v_mul_u32_u24 v13, 4, v4
    s_add_u32 s47, s54, 0
    s_mul_i32 s48, s47, 205
    s_lshr_b32 s48, s48, 11
    s_mul_i32 s49, s48, 10
    s_sub_u32 s49, s47, s49
    s_lshl_b32 s61, s49, 2
    s_add_u32 s61, s61, s44
    s_lshl_b32 s61, s61, 10
    s_mul_i32 s49, s49, 13
    s_add_u32 s49, s49, s48
    s_mul_i32 s57, s49, 49152
    s_mul_i32 s65, s49, 20480
    s_add_u32 s47, s54, 32
    s_mul_i32 s48, s47, 205
    s_lshr_b32 s48, s48, 11
    s_mul_i32 s49, s48, 10
    s_sub_u32 s49, s47, s49
    s_lshl_b32 s62, s49, 2
    s_add_u32 s62, s62, s44
    s_lshl_b32 s62, s62, 10
    s_mul_i32 s49, s49, 13
    s_add_u32 s49, s49, s48
    s_mul_i32 s58, s49, 49152
    s_mul_i32 s66, s49, 20480
    s_add_u32 s47, s54, 64
    s_mul_i32 s48, s47, 205
    s_lshr_b32 s48, s48, 11
    s_mul_i32 s49, s48, 10
    s_sub_u32 s49, s47, s49
    s_lshl_b32 s63, s49, 2
    s_add_u32 s63, s63, s44
    s_lshl_b32 s63, s63, 10
    s_mul_i32 s49, s49, 13
    s_add_u32 s49, s49, s48
    s_mul_i32 s59, s49, 49152
    s_mul_i32 s67, s49, 20480
    s_add_u32 s47, s54, 96
    s_mul_i32 s48, s47, 205
    s_lshr_b32 s48, s48, 11
    s_mul_i32 s49, s48, 10
    s_sub_u32 s49, s47, s49
    s_cmp_ge_u32 s47, 119
    s_cselect_b32 s60, 12, 11
    s_cselect_b32 s68, 9, 0
    s_sub_u32 s68, s47, s68
    s_sub_u32 s68, s68, 110
    s_cmp_ge_u32 s47, 110
    s_cselect_b32 s48, s60, s48
    s_cselect_b32 s49, s68, s49
    s_lshl_b32 s64, s49, 2
    s_add_u32 s64, s64, s44
    s_lshl_b32 s64, s64, 10
    s_mul_i32 s49, s49, 13
    s_add_u32 s49, s49, s48
    s_mul_i32 s60, s49, 49152
    s_mul_i32 s68, s49, 20480
    v_lshrrev_b32 v4, 4, v1
    v_and_b32 v5, 15, v1
    v_mul_u32_u24 v5, 336, v5
    v_lshl_add_u32 v4, v4, 4, v5
    s_mul_i32 s47, s44, 5376
    v_add_u32 v14, s47, v4
    v_min_u32 v4, 39, v1
    v_mul_u32_u24 v5, 26, v4
    v_lshrrev_b32 v5, 8, v5
    v_mul_u32_u24 v6, 10, v5
    v_sub_u32 v4, v4, v6
    s_lshl_b32 s47, s44, 2
    v_add_u32 v5, s47, v5
    v_mul_u32_u24 v15, 336, v5
    v_lshl_add_u32 v15, v4, 5, v15
    v_mul_u32_u24 v5, 1280, v5
    v_lshl_add_u32 v5, v4, 4, v5
    s_lshl_b32 s47, s55, 7
    s_lshl_b32 s48, s55, 5
    s_add_u32 s48, s48, 896
    v_mov_b32 v6, s47
    v_mov_b32 v7, s48
    v_cmp_lt_u32 vcc, 7, v4
    s_nop 1
    v_cndmask_b32 v6, v6, v7, vcc
    v_add_u32 v16, v5, v6
    s_mul_i32 s70, s55, -147456
    s_add_u32 s70, s70, 1572864
    s_waitcnt vmcnt(0)
    s_barrier
    s_cmp_lg_u32 s44, 0
    s_cbranch_scc1 L_rlast
    s_mov_b64 exec, 1
    buffer_store_dword v8, off, s[36:39], s51 sc1
    s_mov_b64 exec, -1
L_rlast:
    s_mov_b32 s51, 212992
    s_mov_b64 s[72:73], 0
    s_mov_b64 s[74:75], 0
    s_buffer_load_dwordx4 s[72:75], s[36:39], s71 offset:0
    s_cmp_eq_u64 s[72:73], s[52:53]
    s_cbranch_scc0 L_pr1s_slow
    s_cmp_eq_u64 s[74:75], s[52:53]
    s_cbranch_scc0 L_pr1s_slow
L_pr1s_out:
    s_mov_b32 s56, 0
    buffer_load_dwordx4 a[0:3], v10, s[28:31], s56 offen offset:0 sc1
    buffer_load_dwordx4 a[4:7], v10, s[28:31], s56 offen offset:1024 sc1
    buffer_load_dwordx4 a[8:11], v10, s[28:31], s56 offen offset:2048 sc1
    buffer_load_dwordx4 a[12:15], v10, s[28:31], s56 offen offset:3072 sc1
    s_mov_b32 s56, 49152
    buffer_load_dwordx4 a[48:51], v10, s[28:31], s56 offen offset:0 sc1
    buffer_load_dwordx4 a[52:55], v10, s[28:31], s56 offen offset:1024 sc1
    buffer_load_dwordx4 a[56:59], v10, s[28:31], s56 offen offset:2048 sc1
    buffer_load_dwordx4 a[60:63], v10, s[28:31], s56 offen offset:3072 sc1
    s_mov_b32 s56, 98304
    buffer_load_dwordx4 a[96:99], v10, s[28:31], s56 offen offset:0 sc1
    buffer_load_dwordx4 a[100:103], v10, s[28:31], s56 offen offset:1024 sc1
    buffer_load_dwordx4 a[104:107], v10, s[28:31], s56 offen offset:2048 sc1
    buffer_load_dwordx4 a[108:111], v10, s[28:31], s56 offen offset:3072 sc1
    s_mov_b64 s[72:73], 0
    s_mov_b64 s[74:75], 0
    s_buffer_load_dwordx4 s[72:75], s[36:39], s71 offset:2048
    s_mov_b32 s56, 147456
    buffer_load_dwordx4 a[144:147], v10, s[28:31], s56 offen offset:0 sc1
    buffer_load_dwordx4 a[148:151], v10, s[28:31], s56 offen offset:1024 sc1
    buffer_load_dwordx4 a[152:155], v10, s[28:31], s56 offen offset:2048 sc1
    buffer_load_dwordx4 a[156:159], v10, s[28:31], s56 offen offset:3072 sc1
    s_add_u32 s56, s70, 0
    buffer_load_dwordx4 a[192:195], v10, s[28:31], s56 offen offset:0 sc1
    buffer_load_dwordx4 a[196:199], v10, s[28:31], s56 offen offset:1024 sc1
    buffer_load_dwordx4 a[200:203], v10, s[28:31], s56 offen offset:2048 sc1
    buffer_load_dwordx4 a[204:207], v10, s[28:31], s56 offen offset:3072 sc1
    s_cmp_eq_u64 s[72:73], s[52:53]
    s_cbranch_scc0 L_pr2s_slow
    s_cmp_eq_u64 s[74:75], s[52:53]
    s_cbranch_scc0 L_pr2s_slow
L_pr2s_out:
    s_mov_b32 s56, 4096
    buffer_load_dwordx4 a[16:19], v10, s[28:31], s56 offen offset:0 sc1
    buffer_load_dwordx4 a[20:23], v10, s[28:31], s56 offen offset:1024 sc1
    buffer_load_dwordx4 a[24:27], v10, s[28:31], s56 offen offset:2048 sc1
    buffer_load_dwordx4 a[28:31], v10, s[28:31], s56 offen offset:3072 sc1
    s_mov_b32 s56, 53248
    buffer_load_dwordx4 a[64:67], v10, s[28:31], s56 offen offset:0 sc1
    buffer_load_dwordx4 a[68:71], v10, s[28:31], s56 offen offset:1024 sc1
    buffer_load_dwordx4 a[72:75], v10, s[28:31], s56 offen offset:2048 sc1
    buffer_load_dwordx4 a[76:79], v10, s[28:31], s56 offen offset:3072 sc1
    s_mov_b32 s56, 102400
    buffer_load_dwordx4 a[112:115], v10, s[28:31], s56 offen offset:0 sc1
    buffer_load_dwordx4 a[116:119], v10, s[28:31], s56 offen offset:1024 sc1
    buffer_load_dwordx4 a[120:123], v10, s[28:31], s56 offen offset:2048 sc1
    buffer_load_dwordx4 a[124:127], v10, s[28:31], s56 offen offset:3072 sc1
    s_mov_b64 s[72:73], 0
    s_mov_b64 s[74:75], 0
    s_buffer_load_dwordx4 s[72:75], s[36:39], s71 offset:4096
    s_mov_b32 s56, 151552
    buffer_load_dwordx4 a[160:163], v10, s[28:31], s56 offen offset:0 sc1
    buffer_load_dwordx4 a[164:167], v10, s[28:31], s56 offen offset:1024 sc1
    buffer_load_dwordx4 a[168:171], v10, s[28:31], s56 offen offset:2048 sc1
    buffer_load_dwordx4 a[172:175], v10, s[28:31], s56 offen offset:3072 sc1
    s_add_u32 s56, s70, 4096
    buffer_load_dwordx4 a[208:211], v10, s[28:31], s56 offen offset:0 sc1
    buffer_load_dwordx4 a[212:215], v10, s[28:31], s56 offen offset:1024 sc1
    buffer_load_dwordx4 a[216:219], v10, s[28:31], s56 offen offset:2048 sc1
    buffer_load_dwordx4 a[220:223], v10, s[28:31], s56 offen offset:3072 sc1
    s_cmp_eq_u64 s[72:73], s[52:53]
    s_cbranch_scc0 L_pr3s_slow
    s_cmp_eq_u64 s[74:75], s[52:53]
    s_cbranch_scc0 L_pr3s_slow
L_pr3s_out:
    s_mov_b32 s56, 8192
    buffer_load_dwordx4 a[32:35], v10, s[28:31], s56 offen offset:0 sc1
    buffer_load_dwordx4 a[36:39], v10, s[28:31], s56 offen offset:1024 sc1
    buffer_load_dwordx4 a[40:43], v10, s[28:31], s56 offen offset:2048 sc1
    buffer_load_dwordx4 a[44:47], v10, s[28:31], s56 offen offset:3072 sc1
    s_mov_b64 s[72:73], 0
    s_mov_b64 s[74:75], 0
    s_mov_b64 s[76:77], 0
    s_buffer_load_dwordx8 s[72:79], s[36:39], s61 offset:0
    s_mov_b32 s56, 57344
    buffer_load_dwordx4 a[80:83], v10, s[28:31], s56 offen offset:0 sc1
    buffer_load_dwordx4 a[84:87], v10, s[28:31], s56 offen offset:1024 sc1
    buffer_load_dwordx4 a[88:91], v10, s[28:31], s56 offen offset:2048 sc1
    buffer_load_dwordx4 a[92:95], v10, s[28:31], s56 offen offset:3072 sc1
    s_mov_b32 s56, 106496
    buffer_load_dwordx4 a[128:131], v10, s[28:31], s56 offen offset:0 sc1
    buffer_load_dwordx4 a[132:135], v10, s[28:31], s56 offen offset:1024 sc1
    buffer_load_dwordx4 a[136:139], v10, s[28:31], s56 offen offset:2048 sc1
    buffer_load_dwordx4 a[140:143], v10, s[28:31], s56 offen offset:3072 sc1
    s_mov_b32 s56, 155648
    buffer_load_dwordx4 a[176:179], v10, s[28:31], s56 offen offset:0 sc1
    buffer_load_dwordx4 a[180:183], v10, s[28:31], s56 offen offset:1024 sc1
    s_waitcnt lgkmcnt(0)
    s_cmp_eq_u64 s[72:73], s[52:53]
    s_cbranch_scc0 L_ph0s_slow
    s_cmp_eq_u64 s[74:75], s[52:53]
    s_cbranch_scc0 L_ph0s_slow
    s_cmp_eq_u64 s[76:77], s[52:53]
    s_cbranch_scc0 L_ph0s_slow
L_ph0s_out:
    s_add_u32 s69, s57, 0
    buffer_load_dwordx4 v[28:31], v11, s[24:27], s69 offen offset:0 sc1
    buffer_load_dwordx4 a[184:187], v10, s[28:31], s56 offen offset:2048 sc1
    buffer_load_dwordx4 a[188:191], v10, s[28:31], s56 offen offset:3072 sc1
    buffer_load_dwordx4 v[32:35], v11, s[24:27], s69 offen offset:1024 sc1
    s_add_u32 s56, s70, 8192
    buffer_load_dwordx4 a[224:227], v10, s[28:31], s56 offen offset:0 sc1
    buffer_load_dwordx4 a[228:231], v10, s[28:31], s56 offen offset:1024 sc1
    buffer_load_dwordx4 v[36:39], v11, s[24:27], s69 offen offset:2048 sc1
    buffer_load_dwordx4 a[232:235], v10, s[28:31], s56 offen offset:2048 sc1
    buffer_load_dwordx4 a[236:239], v10, s[28:31], s56 offen offset:3072 sc1
    buffer_load_dwordx4 v[40:43], v11, s[24:27], s69 offen offset:3072 sc1
    s_add_u32 s69, s57, 4096
    buffer_load_dwordx4 v[44:47], v11, s[24:27], s69 offen offset:0 sc1
    s_mov_b64 s[72:73], 0
    s_mov_b64 s[74:75], 0
    s_mov_b64 s[76:77], 0
    s_buffer_load_dwordx8 s[72:79], s[36:39], s62 offset:40960
    buffer_load_dwordx4 v[48:51], v11, s[24:27], s69 offen offset:1024 sc1
    buffer_load_dwordx4 v[52:55], v11, s[24:27], s69 offen offset:2048 sc1
    buffer_load_dwordx4 v[56:59], v11, s[24:27], s69 offen offset:3072 sc1
    s_add_u32 s69, s57, 8192
    buffer_load_dwordx4 v[60:63], v11, s[24:27], s69 offen offset:0 sc1
    s_waitcnt vmcnt(0)
    s_branch L_join
L_tok_slow:
    s_mov_b32 s50, 0x40000
L_tok_spin:
    buffer_load_dword v8, off, s[32:35], 0 sc1
    s_waitcnt vmcnt(0)
    v_readfirstlane_b32 s52, v8
    s_nop 3
    s_cmp_lg_u32 s52, 0
    s_cbranch_scc1 L_tok_ok
    s_sleep 2
    s_sub_u32 s50, s50, 1
    s_cbranch_scc0 L_tok_spin
    s_branch L_tok_ok
L_pr1_slow:
    s_waitcnt lgkmcnt(0)
    s_cmp_eq_u64 s[72:73], s[52:53]
    s_cbranch_scc0 L_pr1_vec
    s_cmp_eq_u64 s[74:75], s[52:53]
    s_cbranch_scc1 L_pr1_out
L_pr1_vec:
    s_add_u32 s47, s71, 0
    s_mov_b32 s50, 0x40000
L_pr1_spin:
    buffer_load_dword v9, v12, s[36:39], s47 offen sc1
    s_waitcnt vmcnt(0)
    v_cmp_ne_u32 vcc, v9, v8
    s_cbranch_vccz L_pr1_out
    s_sleep 8
    s_sub_u32 s50, s50, 1
    s_cbranch_scc0 L_pr1_spin
    s_branch L_pr1_out
L_pr2_slow:
    s_waitcnt lgkmcnt(0)
    s_cmp_eq_u64 s[72:73], s[52:53]
    s_cbranch_scc0 L_pr2_vec
    s_cmp_eq_u64 s[74:75], s[52:53]
    s_cbranch_scc1 L_pr2_out
L_pr2_vec:
    s_add_u32 s47, s71, 2048
    s_mov_b32 s50, 0x40000
L_pr2_spin:
    buffer_load_dword v9, v12, s[36:39], s47 offen sc1
    s_waitcnt vmcnt(0)
    v_cmp_ne_u32 vcc, v9, v8
    s_cbranch_vccz L_pr2_out
    s_sleep 8
    s_sub_u32 s50, s50, 1
    s_cbranch_scc0 L_pr2_spin
    s_branch L_pr2_out
L_pr3_slow:
    s_waitcnt lgkmcnt(0)
    s_cmp_eq_u64 s[72:73], s[52:53]
    s_cbranch_scc0 L_pr3_vec
    s_cmp_eq_u64 s[74:75], s[52:53]
    s_cbranch_scc1 L_pr3_out
L_pr3_vec:
    s_add_u32 s47, s71, 4096
    s_mov_b32 s50, 0x40000
L_pr3_spin:
    buffer_load_dword v9, v12, s[36:39], s47 offen sc1
    s_waitcnt vmcnt(0)
    v_cmp_ne_u32 vcc, v9, v8
    s_cbranch_vccz L_pr3_out
    s_sleep 8
    s_sub_u32 s50, s50, 1
    s_cbranch_scc0 L_pr3_spin
    s_branch L_pr3_out
L_ph0_slow:
    s_waitcnt lgkmcnt(0)
    s_cmp_eq_u64 s[72:73], s[52:53]
    s_cbranch_scc0 L_ph0_vec
    s_cmp_eq_u64 s[74:75], s[52:53]
    s_cbranch_scc0 L_ph0_vec
    s_cmp_eq_u64 s[76:77], s[52:53]
    s_cbranch_scc1 L_ph0_out
L_ph0_vec:
    s_add_u32 s47, s61, 0
    s_mov_b32 s50, 0x40000
L_ph0_spin:
    buffer_load_dword v9, v13, s[36:39], s47 offen sc1
    s_waitcnt vmcnt(0)
    v_cmp_ne_u32 vcc, v9, v8
    s_cbranch_vccz L_ph0_out
    s_sleep 8
    s_sub_u32 s50, s50, 1
    s_cbranch_scc0 L_ph0_spin
    s_branch L_ph0_out
L_ph1_slow:
    s_waitcnt lgkmcnt(0)
    s_cmp_eq_u64 s[72:73], s[52:53]
    s_cbranch_scc0 L_ph1_vec
    s_cmp_eq_u64 s[74:75], s[52:53]
    s_cbranch_scc0 L_ph1_vec
    s_cmp_eq_u64 s[76:77], s[52:53]
    s_cbranch_scc1 L_ph1_out
L_ph1_vec:
    s_add_u32 s47, s62, 40960
    s_mov_b32 s50, 0x40000
L_ph1_spin:
    buffer_load_dword v9, v13, s[36:39], s47 offen sc1
    s_waitcnt vmcnt(0)
    v_cmp_ne_u32 vcc, v9, v8
    s_cbranch_vccz L_ph1_out
    s_sleep 8
    s_sub_u32 s50, s50, 1
    s_cbranch_scc0 L_ph1_spin
    s_branch L_ph1_out
L_ph2_slow:
    s_waitcnt lgkmcnt(0)
    s_cmp_eq_u64 s[72:73], s[52:53]
    s_cbranch_scc0 L_ph2_vec
    s_cmp_eq_u64 s[74:75], s[52:53]
    s_cbranch_scc0 L_ph2_vec
    s_cmp_eq_u64 s[76:77], s[52:53]
    s_cbranch_scc1 L_ph2_out
L_ph2_vec:
    s_add_u32 s47, s63, 81920
    s_mov_b32 s50, 0x40000
L_ph2_spin:
    buffer_load_dword v9, v13, s[36:39], s47 offen sc1
    s_waitcnt vmcnt(0)
    v_cmp_ne_u32 vcc, v9, v8
    s_cbranch_vccz L_ph2_out
    s_sleep 8
    s_sub_u32 s50, s50, 1
    s_cbranch_scc0 L_ph2_spin
    s_branch L_ph2_out
L_ph3_slow:
    s_waitcnt lgkmcnt(0)
    s_cmp_eq_u64 s[72:73], s[52:53]
    s_cbranch_scc0 L_ph3_vec
    s_cmp_eq_u64 s[74:75], s[52:53]
    s_cbranch_scc0 L_ph3_vec
    s_cmp_eq_u64 s[76:77], s[52:53]
    s_cbranch_scc1 L_ph3_out
L_ph3_vec:
    s_add_u32 s47, s64, 122880
    s_mov_b32 s50, 0x40000
L_ph3_spin:
    buffer_load_dword v9, v13, s[36:39], s47 offen sc1
    s_waitcnt vmcnt(0)
    v_cmp_ne_u32 vcc, v9, v8
    s_cbranch_vccz L_ph3_out
    s_sleep 8
    s_sub_u32 s50, s50, 1
    s_cbranch_scc0 L_ph3_spin
    s_branch L_ph3_out
L_tok2_slow:
    s_mov_b32 s50, 0x40000
L_tok2_spin:
    buffer_load_dword v8, off, s[32:35], 0 sc1
    s_waitcnt vmcnt(0)
    v_readfirstlane_b32 s52, v8
    s_nop 3
    s_cmp_lg_u32 s52, 0
    s_cbranch_scc1 L_tok2_ok
    s_sleep 2
    s_sub_u32 s50, s50, 1
    s_cbranch_scc0 L_tok2_spin
    s_branch L_tok2_ok
L_pr1s_slow:
    s_waitcnt lgkmcnt(0)
    s_cmp_eq_u64 s[72:73], s[52:53]
    s_cbranch_scc0 L_pr1s_vec
    s_cmp_eq_u64 s[74:75], s[52:53]
    s_cbranch_scc1 L_pr1s_out
L_pr1s_vec:
    s_add_u32 s47, s71, 0
    s_mov_b32 s50, 0x40000
L_pr1s_spin:
    buffer_load_dword v9, v12, s[36:39], s47 offen sc1
    s_waitcnt vmcnt(0)
    v_cmp_ne_u32 vcc, v9, v8
    s_cbranch_vccz L_pr1s_out
    s_sleep 8
    s_sub_u32 s50, s50, 1
    s_cbranch_scc0 L_pr1s_spin
    s_branch L_pr1s_out
L_pr2s_slow:
    s_waitcnt lgkmcnt(0)
    s_cmp_eq_u64 s[72:73], s[52:53]
    s_cbranch_scc0 L_pr2s_vec
    s_cmp_eq_u64 s[74:75], s[52:53]
    s_cbranch_scc1 L_pr2s_out
L_pr2s_vec:
    s_add_u32 s47, s71, 2048
    s_mov_b32 s50, 0x40000
L_pr2s_spin:
    buffer_load_dword v9, v12, s[36:39], s47 offen sc1
    s_waitcnt vmcnt(0)
    v_cmp_ne_u32 vcc, v9, v8
    s_cbranch_vccz L_pr2s_out
    s_sleep 8
    s_sub_u32 s50, s50, 1
    s_cbranch_scc0 L_pr2s_spin
    s_branch L_pr2s_out
L_pr3s_slow:
    s_waitcnt lgkmcnt(0)
    s_cmp_eq_u64 s[72:73], s[52:53]
    s_cbranch_scc0 L_pr3s_vec
    s_cmp_eq_u64 s[74:75], s[52:53]
    s_cbranch_scc1 L_pr3s_out
L_pr3s_vec:
    s_add_u32 s47, s71, 4096
    s_mov_b32 s50, 0x40000
L_pr3s_spin:
    buffer_load_dword v9, v12, s[36:39], s47 offen sc1
    s_waitcnt vmcnt(0)
    v_cmp_ne_u32 vcc, v9, v8
    s_cbranch_vccz L_pr3s_out
    s_sleep 8
    s_sub_u32 s50, s50, 1
    s_cbranch_scc0 L_pr3s_spin
    s_branch L_pr3s_out
L_ph0s_slow:
    s_waitcnt lgkmcnt(0)
    s_cmp_eq_u64 s[72:73], s[52:53]
    s_cbranch_scc0 L_ph0s_vec
    s_cmp_eq_u64 s[74:75], s[52:53]
    s_cbranch_scc0 L_ph0s_vec
    s_cmp_eq_u64 s[76:77], s[52:53]
    s_cbranch_scc1 L_ph0s_out
L_ph0s_vec:
    s_add_u32 s47, s61, 0
    s_mov_b32 s50, 0x40000
L_ph0s_spin:
    buffer_load_dword v9, v13, s[36:39], s47 offen sc1
    s_waitcnt vmcnt(0)
    v_cmp_ne_u32 vcc, v9, v8
    s_cbranch_vccz L_ph0s_out
    s_sleep 8
    s_sub_u32 s50, s50, 1
    s_cbranch_scc0 L_ph0s_spin
    s_branch L_ph0s_out
L_codeend:
.section .rodata,"a"
.p2align 6
.amdhsa_kernel standalone__glu_gated_swiglu__prompt_kernel
  .amdhsa_next_free_vgpr 512
  .amdhsa_next_free_sgpr 102
  .amdhsa_accum_offset 256
  .amdhsa_group_segment_fixed_size 0
  .amdhsa_kernarg_size 56
  .amdhsa_user_sgpr_count 2
  .amdhsa_user_sgpr_kernarg_segment_ptr 1
  .amdhsa_system_sgpr_workgroup_id_x 1
  .amdhsa_float_denorm_mode_32 3
.end_amdhsa_kernel
```
